```python
import torch

def _softmax(x, axis=-1):
    return torch.softmax(x, dim=axis)

def _gelu(x):
    return torch.nn.functional.gelu(x, approximate='tanh')

def _silu(x):
    return torch.nn.functional.silu(x)

def _sigmoid(x):
    return torch.sigmoid(x)

def _layernorm(x, axis=-1, eps=1e-05):
    m = x.mean(dim=axis, keepdim=True)
    v = x.var(dim=axis, keepdim=True, unbiased=False)
    return (x - m) / torch.sqrt(v + eps)

def _scatter_add(tgt, idx, src, axis=0):
    return tgt.clone().index_add_(axis, idx, src)

def _segment_sum(src, seg, n):
    out = torch.zeros((n,) + src.shape[1:], dtype=src.dtype)
    return out.index_add_(0, seg, src)

def _pad(x, pw):
    flat = tuple((v for pair in reversed(pw) for v in pair))
    return torch.nn.functional.pad(x, flat)
kernel_name = 'gather_scatter__tensor_product_equiv_equiformer__graph'

def setup_inputs():

    _w = lambda a: (lambda t: t.to(torch.bfloat16) if t.is_floating_point() else t)(torch.as_tensor(a))
    N, deg, C, De = (10000, 64, 64, max(0, 1))
    E = N * deg
    src = (lambda lo, hi, *s: torch.randint(lo, hi, s))(0, N, E).to(torch.int64)
    dst = (lambda lo, hi, *s: torch.randint(lo, hi, s))(0, N, E).to(torch.int64)
    rvec = (lambda *s: torch.randn(*s, dtype=torch.bfloat16) * 0.05)(E, 3).to(float)
    rn = (torch.linalg.norm(rvec, dim=-1, keepdim=True) + 1e-06).to(float)
    rhat = (rvec / rn).to(float)
    eps = torch.zeros((3, 3, 3), dtype=float)
    eps[0, 1, 2] = eps[1, 2, 0] = eps[2, 0, 1] = 1.0
    eps[0, 2, 1] = eps[2, 1, 0] = eps[1, 0, 2] = -1.0
    return {'x': _w((lambda *s: torch.randn(*s, dtype=torch.bfloat16) * 0.4)(N, 4 * C).to(float)), 'rhat': _w(rhat), 'e_attr': _w((lambda *s: torch.randn(*s, dtype=torch.bfloat16) * 0.4)(E, De).to(float)), 'src': _w(src), 'dst': _w(dst), 'w_rad': _w((lambda *s: torch.randn(*s, dtype=torch.bfloat16) * 0.4)(De, 5 * C).to(float)), 'w_si0': _w((lambda *s: torch.randn(*s, dtype=torch.bfloat16) * 0.4)(2 * C, C).to(float)), 'w_si1': _w((lambda *s: torch.randn(*s, dtype=torch.bfloat16) * 0.05)(3 * C, C).to(float)), 'cg_eps': _w(eps)}

def reference(x, rhat, e_attr, src, dst, w_rad, w_si0, w_si1, cg_eps):
    N = x.shape[0]
    C = w_si0.shape[1]
    E = rhat.shape[0]
    x0 = x[:, :C].clone()
    x1 = x[:, C:].reshape(N, 3, C)
    R = (e_attr @ w_rad).reshape(E, 5, C)
    f0 = x0[src]
    f1 = x1[src]
    Y1 = rhat
    p00_0 = f0 * R[:, 0, :]
    p11_0 = torch.einsum('ejc,ej->ec', f1, Y1) * R[:, 1, :]
    p01_1 = torch.einsum('ec,ej->ejc', f0, Y1) * R[:, 2, :][:, None, :]
    p10_1 = f1 * R[:, 3, :][:, None, :]
    p11_1 = torch.einsum('ijk,ekc,ej->eic', cg_eps, f1, Y1) * R[:, 4, :][:, None, :]
    m0 = torch.concatenate([p00_0, p11_0], axis=-1) @ w_si0
    m1 = torch.einsum('ejp,pc->ejc', torch.concatenate([p01_1, p10_1, p11_1], axis=-1), w_si1)
    agg0 = _segment_sum(m0, dst, N)
    agg1 = _segment_sum(m1.reshape(E, 3 * C), dst, N).reshape(N, 3, C)
    gate = _sigmoid(agg0)
    out1 = agg1 * gate[:, None, :]
    return torch.concatenate([agg0, out1.reshape(N, 3 * C)], axis=-1)
```

```asm
; @launch grid=(256,1,1) block=(768,1,1) lds=115200
.amdgcn_target "amdgcn-amd-amdhsa--gfx950"
.text
.globl gather_scatter__tensor_product_equiv_equiformer__graph_kernel
.p2align 8
.type gather_scatter__tensor_product_equiv_equiformer__graph_kernel,@function
gather_scatter__tensor_product_equiv_equiformer__graph_kernel:
    s_cmp_ge_u32 s2, 256
    s_cbranch_scc1 L_end
    s_load_dwordx4 s[40:43], s[0:1], 8
    s_load_dwordx4 s[44:47], s[0:1], 24
    s_load_dwordx2 s[6:7], s[0:1], 88
    s_load_dwordx2 s[4:5], s[0:1], 0
    s_load_dwordx2 s[8:9], s[0:1], 72
    s_load_dwordx4 s[60:63], s[0:1], 40
    s_load_dwordx2 s[64:65], s[0:1], 56
    v_lshrrev_b32 v1, 6, v0
    v_lshlrev_b32 v2, 3, v0
    v_readfirstlane_b32 s3, v1
    v_mul_u32_u24 v3, 24, v0
    v_lshlrev_b32 v1, 4, v0
    v_cmp_gt_u32 vcc, 625, v0
    s_mov_b32 s73, 0
    s_cmp_ge_u32 s3, 10
    s_cbranch_scc1 L_help
    s_mov_b32 s53, s2
    s_mul_i32 s54, s53, 10000
    s_mul_i32 s55, s53, 5000
    s_mul_i32 s56, s53, 15000
    s_mul_i32 s57, s2, 30720
    s_mov_b64 exec, vcc
    s_waitcnt lgkmcnt(0)
    s_add_u32 s46, s46, s54
    s_addc_u32 s47, s47, 0
    global_load_dwordx4 v[4:7], v1, s[46:47] nt
    s_barrier
    s_add_u32 s44, s44, s54
    s_addc_u32 s45, s45, 0
    global_load_dwordx4 v[8:11], v1, s[44:45] nt
    s_add_u32 s42, s42, s55
    s_addc_u32 s43, s43, 0
    global_load_dwordx2 v[12:13], v2, s[42:43] nt
    s_mov_b32 s51, s56
    s_add_u32 s48, s6, s57
    s_addc_u32 s49, s7, 0
    s_mov_b32 s54, 214749
    s_mov_b32 s55, 6711
    s_mov_b32 s56, 0xffff0000
    s_movk_i32 s57, 4096
    s_movk_i32 s58, 625
    v_mov_b32 v46, 1
    s_mov_b64 s[52:53], exec
    s_mov_b64 exec, -1
    v_mov_b32 v96, 0
    v_mov_b32 v97, 0
    v_mov_b32 v98, 0
    v_mov_b32 v99, 0
    v_mov_b32 v100, 0
    v_mov_b32 v101, 0
    v_mov_b32 v102, 0
    v_mov_b32 v103, 0
    v_mov_b32 v104, 0
    v_mov_b32 v105, 0
    v_mov_b32 v106, 0
    v_mov_b32 v107, 0
    v_mov_b32 v108, 0
    v_mov_b32 v109, 0
    v_mov_b32 v110, 0
    v_mov_b32 v111, 0
    v_mov_b32 v112, 0
    v_mov_b32 v113, 0
    v_mov_b32 v114, 0
    v_mov_b32 v115, 0
    v_mov_b32 v116, 0
    v_mov_b32 v117, 0
    v_mov_b32 v118, 0
    v_mov_b32 v119, 0
    v_mov_b32 v120, 0
    v_mov_b32 v121, 0
    v_mov_b32 v122, 0
    v_mov_b32 v123, 0
    v_mov_b32 v124, 0
    v_mov_b32 v125, 0
    v_mov_b32 v126, 0
    v_mov_b32 v127, 0
    v_mov_b32 v128, 0
    v_mov_b32 v129, 0
    v_mov_b32 v130, 0
    v_mov_b32 v131, 0
    v_mov_b32 v132, 0
    v_mov_b32 v133, 0
    v_mov_b32 v134, 0
    v_mov_b32 v135, 0
    v_mov_b32 v136, 0
    v_mov_b32 v137, 0
    v_mov_b32 v138, 0
    v_mov_b32 v139, 0
    v_mov_b32 v140, 0
    v_mov_b32 v141, 0
    v_mov_b32 v142, 0
    v_mov_b32 v143, 0
    v_mov_b32 v144, 0
    v_mov_b32 v145, 0
    v_mov_b32 v146, 0
    v_mov_b32 v147, 0
    v_mov_b32 v148, 0
    v_mov_b32 v149, 0
    v_mov_b32 v150, 0
    v_mov_b32 v151, 0
    v_mov_b32 v152, 0
    v_mov_b32 v153, 0
    v_mov_b32 v154, 0
    v_mov_b32 v155, 0
    v_mov_b32 v156, 0
    v_mov_b32 v157, 0
    v_mov_b32 v158, 0
    v_mov_b32 v159, 0
    s_mov_b64 exec, s[52:53]
    s_waitcnt vmcnt(2)
    v_mul_u32_u24 v20, s54, v4
    v_lshrrev_b32 v20, 23, v20
    v_mad_u32_u24 v48, v20, s58, 15
    v_lshlrev_b32 v20, 2, v20
    ds_add_rtn_u32 v24, v20, v46 offset:2048
    v_mul_u32_u24 v21, s54, v5
    v_lshrrev_b32 v21, 23, v21
    v_mad_u32_u24 v49, v21, s58, 15
    v_lshlrev_b32 v21, 2, v21
    ds_add_rtn_u32 v25, v21, v46 offset:2048
    v_mul_u32_u24 v22, s54, v6
    v_lshrrev_b32 v22, 23, v22
    v_mad_u32_u24 v50, v22, s58, 15
    v_lshlrev_b32 v22, 2, v22
    ds_add_rtn_u32 v26, v22, v46 offset:2048
    v_mul_u32_u24 v23, s54, v7
    v_lshrrev_b32 v23, 23, v23
    v_mad_u32_u24 v51, v23, s58, 15
    v_lshlrev_b32 v23, 2, v23
    ds_add_rtn_u32 v27, v23, v46 offset:2048
    s_add_u32 s40, s40, s51
    s_addc_u32 s41, s41, 0
    global_load_dwordx4 v[14:17], v3, s[40:41] nt
    global_load_dwordx2 v[18:19], v3, s[40:41] offset:16 nt
    v_lshrrev_b32 v48, 4, v48
    v_sub_u32 v4, v4, v48
    v_lshlrev_b32 v4, 2, v4
    v_lshrrev_b32 v49, 4, v49
    v_sub_u32 v5, v5, v49
    v_lshlrev_b32 v5, 2, v5
    v_lshrrev_b32 v50, 4, v50
    v_sub_u32 v6, v6, v50
    v_lshlrev_b32 v6, 2, v6
    v_lshrrev_b32 v51, 4, v51
    v_sub_u32 v7, v7, v51
    v_lshlrev_b32 v7, 2, v7
    s_waitcnt lgkmcnt(0)
    s_barrier
    ds_read_b32 v4, v4 offset:1088
    ds_read_b32 v5, v5 offset:1088
    ds_read_b32 v6, v6 offset:1088
    ds_read_b32 v7, v7 offset:1088
    s_waitcnt vmcnt(3)
    v_mul_u32_u24 v48, s55, v8
    v_lshrrev_b32 v48, 21, v48
    v_bfe_u32 v49, v20, 7, 3
    v_lshl_add_u32 v48, v49, 2, v48
    v_and_b32 v48, 28, v48
    v_lshl_or_b32 v30, v8, 9, v48
    v_mul_u32_u24 v48, s55, v9
    v_lshrrev_b32 v48, 21, v48
    v_bfe_u32 v49, v21, 7, 3
    v_lshl_add_u32 v48, v49, 2, v48
    v_and_b32 v48, 28, v48
    v_lshl_or_b32 v34, v9, 9, v48
    v_mul_u32_u24 v48, s55, v10
    v_lshrrev_b32 v48, 21, v48
    v_bfe_u32 v49, v22, 7, 3
    v_lshl_add_u32 v48, v49, 2, v48
    v_and_b32 v48, 28, v48
    v_lshl_or_b32 v38, v10, 9, v48
    v_mul_u32_u24 v48, s55, v11
    v_lshrrev_b32 v48, 21, v48
    v_bfe_u32 v49, v23, 7, 3
    v_lshl_add_u32 v48, v49, 2, v48
    v_and_b32 v48, 28, v48
    v_lshl_or_b32 v42, v11, 9, v48
    s_waitcnt lgkmcnt(0)
    v_or_b32 v30, v30, v4
    v_or_b32 v34, v34, v5
    v_or_b32 v38, v38, v6
    v_or_b32 v42, v42, v7
    s_barrier
    ds_read_b32 v4, v20 offset:3072
    ds_read_b32 v5, v21 offset:3072
    ds_read_b32 v6, v22 offset:3072
    ds_read_b32 v7, v23 offset:3072
    s_waitcnt lgkmcnt(3)
    v_add_u32 v4, v4, v24
    v_mad_u32_u24 v4, v4, 12, s57
    ds_write_b32 v4, v30 offset:8
    s_waitcnt lgkmcnt(3)
    v_add_u32 v5, v5, v25
    v_mad_u32_u24 v5, v5, 12, s57
    ds_write_b32 v5, v34 offset:8
    s_waitcnt lgkmcnt(3)
    v_add_u32 v6, v6, v26
    v_mad_u32_u24 v6, v6, 12, s57
    ds_write_b32 v6, v38 offset:8
    s_waitcnt lgkmcnt(3)
    v_add_u32 v7, v7, v27
    v_mad_u32_u24 v7, v7, 12, s57
    ds_write_b32 v7, v42 offset:8
    s_mov_b64 s[52:53], exec
    s_mov_b64 exec, -1
    s_sub_u32 s64, s64, 16384
    s_subb_u32 s65, s65, 0
    s_cmp_lt_u32 s3, 8
    s_cselect_b32 s62, s62, s64
    s_cselect_b32 s63, s63, s65
    s_add_u32 s64, s64, 20480
    s_addc_u32 s65, s65, 0
    v_and_b32 v84, 0xffffff80, v1
    v_add_u32 v84, v84, v1
    v_lshrrev_b32 v85, 7, v1
    v_lshlrev_b32 v86, 2, v85
    global_load_dwordx4 v[64:67], v84, s[62:63]
    global_load_dwordx4 v[68:71], v84, s[62:63] offset:128
    global_load_dwordx4 v[72:75], v84, s[64:65]
    global_load_dwordx4 v[76:79], v84, s[64:65] offset:128
    global_load_dword v80, v86, s[60:61]
    global_load_dword v81, v86, s[60:61] offset:320
    s_mov_b64 exec, s[52:53]
    s_waitcnt vmcnt(8)
    v_lshlrev_b32 v48, 16, v12
    v_and_b32 v49, s56, v12
    v_lshlrev_b32 v50, 16, v13
    v_and_b32 v51, s56, v13
    s_waitcnt vmcnt(7)
    v_lshlrev_b32 v52, 16, v14
    v_mul_f32 v52, v48, v52
    v_and_b32 v53, s56, v14
    v_mul_f32 v53, v48, v53
    v_lshlrev_b32 v54, 16, v15
    v_mul_f32 v54, v48, v54
    v_cvt_pk_bf16_f32 v28, v48, v52
    v_cvt_pk_bf16_f32 v29, v53, v54
    ds_write2_b32 v4, v28, v29 offset0:0 offset1:1
    v_and_b32 v55, s56, v15
    v_mul_f32 v55, v49, v55
    v_lshlrev_b32 v56, 16, v16
    v_mul_f32 v56, v49, v56
    v_and_b32 v57, s56, v16
    v_mul_f32 v57, v49, v57
    v_cvt_pk_bf16_f32 v32, v49, v55
    v_cvt_pk_bf16_f32 v33, v56, v57
    ds_write2_b32 v5, v32, v33 offset0:0 offset1:1
    s_waitcnt vmcnt(6)
    v_lshlrev_b32 v58, 16, v17
    v_mul_f32 v58, v50, v58
    v_and_b32 v59, s56, v17
    v_mul_f32 v59, v50, v59
    v_lshlrev_b32 v60, 16, v18
    v_mul_f32 v60, v50, v60
    v_cvt_pk_bf16_f32 v36, v50, v58
    v_cvt_pk_bf16_f32 v37, v59, v60
    ds_write2_b32 v6, v36, v37 offset0:0 offset1:1
    v_and_b32 v61, s56, v18
    v_mul_f32 v61, v51, v61
    v_lshlrev_b32 v62, 16, v19
    v_mul_f32 v62, v51, v62
    v_and_b32 v63, s56, v19
    v_mul_f32 v63, v51, v63
    v_cvt_pk_bf16_f32 v40, v51, v61
    v_cvt_pk_bf16_f32 v41, v62, v63
    ds_write2_b32 v7, v40, v41 offset0:0 offset1:1
    s_waitcnt lgkmcnt(0)
    s_barrier
    s_mov_b64 exec, -1
    ds_read_b128 v[28:31], v1 offset:4096
    ds_read_b128 v[32:35], v1 offset:14336
    ds_read_b128 v[36:39], v1 offset:24576
    v_add_u32 v2, 10240, v1
    v_add_u32 v3, 20480, v1
    v_and_b32 v0, 63, v0
    s_waitcnt lgkmcnt(2)
    global_store_dwordx4 v1, v[28:31], s[48:49] sc1
    s_waitcnt lgkmcnt(1)
    global_store_dwordx4 v2, v[32:35], s[48:49] sc1
    s_waitcnt lgkmcnt(0)
    global_store_dwordx4 v3, v[36:39], s[48:49] sc1
    v_lshrrev_b32 v85, 7, v1
    v_and_b32 v84, 0x70, v1
    v_lshlrev_b32 v84, 1, v84
    v_lshrrev_b32 v86, 5, v85
    v_lshl_or_b32 v82, v86, 13, v84
    v_bfe_u32 v86, v85, 3, 1
    v_lshl_or_b32 v82, v86, 12, v82
    v_bfe_u32 v86, v85, 4, 1
    v_lshl_or_b32 v82, v86, 8, v82
    v_bfe_u32 v86, v85, 1, 1
    v_lshl_or_b32 v82, v86, 9, v82
    v_bfe_u32 v86, v85, 2, 1
    v_lshl_or_b32 v82, v86, 3, v82
    v_bfe_u32 v86, v85, 0, 1
    v_lshl_or_b32 v82, v86, 2, v82
    v_add_u32 v85, 80, v85
    v_lshrrev_b32 v86, 5, v85
    v_lshl_or_b32 v83, v86, 13, v84
    v_bfe_u32 v86, v85, 3, 1
    v_lshl_or_b32 v83, v86, 12, v83
    v_bfe_u32 v86, v85, 4, 1
    v_lshl_or_b32 v83, v86, 8, v83
    v_bfe_u32 v86, v85, 1, 1
    v_lshl_or_b32 v83, v86, 9, v83
    v_bfe_u32 v86, v85, 2, 1
    v_lshl_or_b32 v83, v86, 3, v83
    v_bfe_u32 v86, v85, 0, 1
    v_lshl_or_b32 v83, v86, 2, v83
    v_add_u32 v82, 74240, v82
    v_add_u32 v83, 74240, v83
    s_waitcnt vmcnt(3)
    s_mov_b32 s11, 0xffff0000
    v_lshlrev_b32 v84, 16, v80
    v_and_b32 v85, s11, v80
    v_lshlrev_b32 v86, 16, v64
    v_lshlrev_b32 v87, 16, v68
    v_mul_f32 v86, v86, v84
    v_mul_f32 v87, v87, v85
    v_cvt_pk_bf16_f32 v86, v86, v87
    ds_write_b32 v82, v86 offset:0
    v_and_b32 v88, s11, v64
    v_and_b32 v89, s11, v68
    v_mul_f32 v88, v88, v84
    v_mul_f32 v89, v89, v85
    v_cvt_pk_bf16_f32 v88, v88, v89
    ds_write_b32 v82, v88 offset:1024
    v_lshlrev_b32 v86, 16, v65
    v_lshlrev_b32 v87, 16, v69
    v_mul_f32 v86, v86, v84
    v_mul_f32 v87, v87, v85
    v_cvt_pk_bf16_f32 v86, v86, v87
    ds_write_b32 v82, v86 offset:2048
    v_and_b32 v88, s11, v65
    v_and_b32 v89, s11, v69
    v_mul_f32 v88, v88, v84
    v_mul_f32 v89, v89, v85
    v_cvt_pk_bf16_f32 v88, v88, v89
    ds_write_b32 v82, v88 offset:3072
    v_lshlrev_b32 v86, 16, v66
    v_lshlrev_b32 v87, 16, v70
    v_mul_f32 v86, v86, v84
    v_mul_f32 v87, v87, v85
    v_cvt_pk_bf16_f32 v86, v86, v87
    ds_write_b32 v82, v86 offset:16
    v_and_b32 v88, s11, v66
    v_and_b32 v89, s11, v70
    v_mul_f32 v88, v88, v84
    v_mul_f32 v89, v89, v85
    v_cvt_pk_bf16_f32 v88, v88, v89
    ds_write_b32 v82, v88 offset:1040
    v_lshlrev_b32 v86, 16, v67
    v_lshlrev_b32 v87, 16, v71
    v_mul_f32 v86, v86, v84
    v_mul_f32 v87, v87, v85
    v_cvt_pk_bf16_f32 v86, v86, v87
    ds_write_b32 v82, v86 offset:2064
    v_and_b32 v88, s11, v67
    v_and_b32 v89, s11, v71
    v_mul_f32 v88, v88, v84
    v_mul_f32 v89, v89, v85
    v_cvt_pk_bf16_f32 v88, v88, v89
    ds_write_b32 v82, v88 offset:3088
    s_waitcnt lgkmcnt(4)
    v_lshlrev_b32 v84, 16, v81
    v_and_b32 v85, s11, v81
    v_lshlrev_b32 v86, 16, v72
    v_lshlrev_b32 v87, 16, v76
    v_mul_f32 v86, v86, v84
    v_mul_f32 v87, v87, v85
    v_cvt_pk_bf16_f32 v86, v86, v87
    ds_write_b32 v83, v86 offset:0
    v_and_b32 v88, s11, v72
    v_and_b32 v89, s11, v76
    v_mul_f32 v88, v88, v84
    v_mul_f32 v89, v89, v85
    v_cvt_pk_bf16_f32 v88, v88, v89
    ds_write_b32 v83, v88 offset:1024
    v_lshlrev_b32 v86, 16, v73
    v_lshlrev_b32 v87, 16, v77
    v_mul_f32 v86, v86, v84
    v_mul_f32 v87, v87, v85
    v_cvt_pk_bf16_f32 v86, v86, v87
    ds_write_b32 v83, v86 offset:2048
    v_and_b32 v88, s11, v73
    v_and_b32 v89, s11, v77
    v_mul_f32 v88, v88, v84
    v_mul_f32 v89, v89, v85
    v_cvt_pk_bf16_f32 v88, v88, v89
    ds_write_b32 v83, v88 offset:3072
    v_lshlrev_b32 v86, 16, v74
    v_lshlrev_b32 v87, 16, v78
    v_mul_f32 v86, v86, v84
    v_mul_f32 v87, v87, v85
    v_cvt_pk_bf16_f32 v86, v86, v87
    ds_write_b32 v83, v86 offset:16
    v_and_b32 v88, s11, v74
    v_and_b32 v89, s11, v78
    v_mul_f32 v88, v88, v84
    v_mul_f32 v89, v89, v85
    v_cvt_pk_bf16_f32 v88, v88, v89
    ds_write_b32 v83, v88 offset:1040
    v_lshlrev_b32 v86, 16, v75
    v_lshlrev_b32 v87, 16, v79
    v_mul_f32 v86, v86, v84
    v_mul_f32 v87, v87, v85
    v_cvt_pk_bf16_f32 v86, v86, v87
    ds_write_b32 v83, v86 offset:2064
    v_and_b32 v88, s11, v75
    v_and_b32 v89, s11, v79
    v_mul_f32 v88, v88, v84
    v_mul_f32 v89, v89, v85
    v_cvt_pk_bf16_f32 v88, v88, v89
    ds_write_b32 v83, v88 offset:3088
    s_waitcnt lgkmcnt(0)
L_common:
    v_mov_b32 v44, 520
    s_mov_b32 s12, s4
    s_mov_b32 s13, s5
    s_mov_b32 s14, 5120000
    s_mov_b32 s15, 0x20000
    s_and_b32 s68, s2, 7
    s_lshl_b32 s68, s68, 5
    s_lshr_b32 s69, s2, 3
    s_add_u32 s69, s69, s68
    s_lshl_b32 s68, s69, 3
    s_add_u32 s68, s68, 8388608
    s_add_u32 s16, s6, s68
    s_addc_u32 s17, s7, 0
    s_mov_b32 s18, 524288
    s_mov_b32 s19, 0x20000
    s_mov_b32 s20, s6
    s_mov_b32 s21, s7
    s_mov_b32 s22, 7864320
    s_mov_b32 s23, 0x20000
    v_and_b32 v166, 3, v0
    v_cmp_eq_u32 s[58:59], 0, v166
    v_cmp_eq_u32 s[60:61], 1, v166
    v_cmp_eq_u32 s[62:63], 2, v166
    v_cmp_eq_u32 s[64:65], 3, v166
    v_bfrev_b32 v166, 4
    v_cndmask_b32 v163, 0, 1.0, s[62:63]
    v_cndmask_b32 v164, 0, 1.0, s[64:65]
    v_cndmask_b32 v165, 0, 1.0, s[60:61]
    v_cndmask_b32 v160, v165, 1.0, s[58:59]
    v_cndmask_b32 v161, v163, 1.0, s[58:59]
    v_cndmask_b32 v162, v164, 1.0, s[58:59]
    v_cndmask_b32 v163, v163, -1.0, s[64:65]
    v_cndmask_b32 v164, v164, -1.0, s[60:61]
    v_cndmask_b32 v165, v165, -1.0, s[62:63]
    s_mul_i32 s58, s3, 22
    s_sub_u32 s59, 256, s58
    s_min_u32 s59, s59, 22
    s_bfm_b64 s[60:61], s59, 0
    v_add_u32 v45, s58, v0
    s_mov_b32 s10, 30720
    v_mul_lo_u32 v46, v45, s10
    v_lshlrev_b32 v45, 11, v45
    v_lshrrev_b32 v4, 4, v0
    v_lshlrev_b32 v167, 3, v4
    v_lshlrev_b32 v4, 2, v4
    v_and_b32 v5, 15, v0
    v_lshlrev_b32 v1, 4, v5
    v_add_u32 v5, 1, v5
    v_mov_b32 v2, 0
    s_cmp_eq_u32 s73, 0
    s_cbranch_scc1 L_drain
    s_mov_b32 s10, 200000
    s_branch L_hchk
L_hpoll:
    global_load_dword v41, v40, s[66:67] sc1
    s_sub_u32 s10, s10, 1
    s_cbranch_scc1 L_end
L_hchk:
    s_waitcnt vmcnt(0)
    v_cmp_eq_u32 vcc, 0, v41
    s_cbranch_vccnz L_hpoll
    ds_write_b32 v44, v41
    v_and_b32 v42, 0xff000000, v41
    v_xor_b32 v42, 0xa5000000, v42
    v_lshl_or_b32 v48, v50, 12, v48
    v_lshl_or_b32 v50, v51, 12, v49
    v_lshl_or_b32 v52, v54, 12, v52
    v_lshl_or_b32 v54, v55, 12, v53
    v_or_b32 v48, v42, v48
    v_or_b32 v50, v42, v50
    v_or_b32 v52, v42, v52
    v_or_b32 v54, v42, v54
    v_mov_b32 v49, v41
    v_mov_b32 v51, v41
    v_mov_b32 v53, v41
    v_mov_b32 v55, v41
    s_waitcnt lgkmcnt(0)
    s_barrier
    global_store_dwordx4 v62, v[48:51], s[50:51] sc1
    global_store_dwordx4 v62, v[52:55], s[50:51] offset:1024 sc1
    s_branch L_nopub
L_drain:
    s_waitcnt vmcnt(0)
    s_barrier
L_nopub:
    ds_read_b32 v44, v44
    s_waitcnt lgkmcnt(0)
    v_readfirstlane_b32 s70, v44
    s_and_b32 s71, s70, 0xff000000
    s_xor_b32 s71, s71, 0xa5000000
    s_mov_b32 s10, 200000
    s_sub_u32 s59, s59, 1
    s_bfm_b64 exec, 1, s59
L_poll0:
    buffer_load_dwordx2 v[6:7], v45, s[16:19], 0 offen sc1
    s_sub_u32 s10, s10, 1
    s_cbranch_scc1 L_end
    s_waitcnt vmcnt(0)
    v_cmp_ne_u32 vcc, s70, v7
    s_cbranch_vccnz L_poll0
    s_mov_b64 exec, s[60:61]
L_poll:
    buffer_load_dwordx2 v[6:7], v45, s[16:19], 0 offen sc1
    s_sub_u32 s10, s10, 1
    s_cbranch_scc1 L_end
    s_waitcnt vmcnt(0)
    v_xor_b32 v2, s71, v6
    v_xor_b32 v7, s70, v7
    v_lshrrev_b32 v6, 24, v2
    v_or_b32 v6, v6, v7
    v_cmp_ne_u32 vcc, 0, v6
    s_and_b64 exec, exec, vcc
    s_cbranch_scc1 L_poll
    s_mov_b64 exec, -1
    v_and_b32 v3, 0xfff, v2
    v_lshrrev_b32 v2, 12, v2
    v_mad_u32_u24 v3, v3, 12, v46
L_round:
    v_mad_u32_u24 v31, v5, 12, -12
    v_cmp_lt_u32 vcc, 16, v2
    ds_bpermute_b32 v42, v4, v3 offset:0
    ds_bpermute_b32 v49, v4, v2 offset:0
    ds_bpermute_b32 v43, v4, v3 offset:16
    ds_bpermute_b32 v50, v4, v2 offset:16
    ds_bpermute_b32 v44, v4, v3 offset:32
    ds_bpermute_b32 v51, v4, v2 offset:32
    ds_bpermute_b32 v45, v4, v3 offset:48
    ds_bpermute_b32 v52, v4, v2 offset:48
    ds_bpermute_b32 v46, v4, v3 offset:64
    ds_bpermute_b32 v53, v4, v2 offset:64
    s_brev_b32 s11, 1
    s_waitcnt lgkmcnt(8)
    v_sub_u32 v49, v49, v5
    v_add_u32 v42, v42, v31
    v_and_or_b32 v42, v49, s11, v42
    buffer_load_dwordx3 v[64:66], v42, s[20:23], 0 offen sc1
    s_waitcnt lgkmcnt(6)
    v_sub_u32 v50, v50, v5
    v_add_u32 v43, v43, v31
    v_and_or_b32 v43, v50, s11, v43
    buffer_load_dwordx3 v[68:70], v43, s[20:23], 0 offen sc1
    s_waitcnt lgkmcnt(4)
    v_sub_u32 v51, v51, v5
    v_add_u32 v44, v44, v31
    v_and_or_b32 v44, v51, s11, v44
    buffer_load_dwordx3 v[72:74], v44, s[20:23], 0 offen sc1
    s_waitcnt lgkmcnt(2)
    v_sub_u32 v52, v52, v5
    v_add_u32 v45, v45, v31
    v_and_or_b32 v45, v52, s11, v45
    buffer_load_dwordx3 v[76:78], v45, s[20:23], 0 offen sc1
    s_waitcnt lgkmcnt(0)
    v_sub_u32 v53, v53, v5
    v_add_u32 v46, v46, v31
    v_and_or_b32 v46, v53, s11, v46
    buffer_load_dwordx3 v[80:82], v46, s[20:23], 0 offen sc1
    s_mov_b64 s[36:37], vcc
    s_ff1_i32_b64 s10, s[36:37]
    s_bitset0_b64 s[36:37], s10
    s_ff1_i32_b64 s11, s[36:37]
    s_bitset0_b64 s[36:37], s11
    s_and_b32 s10, s10, 63
    s_lshl_b32 s11, s11, 26
    s_lshl_b32 s10, s10, 18
    s_or_b32 s11, s11, 0x5450
    s_or_b32 s10, s10, s11
    v_and_b32 v7, 32, v0
    v_lshrrev_b32 v7, 1, v7
    v_bfe_u32 v6, s10, v167, 8
    s_cmp_lg_u64 s[36:37], 0
    s_cselect_b32 s32, 1, 0
    s_cbranch_scc0 L_no8
    s_ff1_i32_b64 s11, s[36:37]
    s_bitset0_b64 s[36:37], s11
    s_lshl_b32 s11, s11, 2
    s_and_b32 s11, s11, 0xfc
    s_mov_b32 s10, s11
    s_ff1_i32_b64 s11, s[36:37]
    s_bitset0_b64 s[36:37], s11
    s_lshl_b32 s11, s11, 2
    s_and_b32 s11, s11, 0xfc
    s_lshl_b32 s11, s11, 8
    s_or_b32 s10, s10, s11
    s_ff1_i32_b64 s11, s[36:37]
    s_bitset0_b64 s[36:37], s11
    s_lshl_b32 s11, s11, 2
    s_and_b32 s11, s11, 0xfc
    s_lshl_b32 s11, s11, 16
    s_or_b32 s10, s10, s11
    s_ff1_i32_b64 s11, s[36:37]
    s_bitset0_b64 s[36:37], s11
    s_lshl_b32 s11, s11, 2
    s_and_b32 s11, s11, 0xfc
    s_lshl_b32 s11, s11, 24
    s_or_b32 s10, s10, s11
    v_bfe_u32 v13, s10, v167, 8
    s_brev_b32 s11, 1
    ds_bpermute_b32 v14, v13, v3
    ds_bpermute_b32 v15, v13, v2
    s_waitcnt lgkmcnt(0)
    v_add_u32 v15, -16, v15
    v_sub_u32 v15, v15, v5
    v_add_u32 v14, v14, v31
    v_and_or_b32 v14, v15, s11, v14
    buffer_load_dwordx3 v[8:10], v14, s[20:23], 0 offen offset:192 sc1
L_no8:
    s_xor_b64 s[36:37], s[36:37], vcc
    s_brev_b32 s11, 1
    ds_bpermute_b32 v47, v6, v3
    ds_bpermute_b32 v54, v6, v2
    s_waitcnt lgkmcnt(0)
    v_sub_u32 v54, v54, v7
    v_mad_u32_u24 v47, v7, 12, v47
    v_sub_u32 v54, v54, v5
    v_add_u32 v47, v47, v31
    v_and_or_b32 v47, v54, s11, v47
    buffer_load_dwordx3 v[84:86], v47, s[20:23], 0 offen sc1
    v_cndmask_b32 v6, 16, 32, s[36:37]
    v_sub_u32 v2, v2, v6
    v_mad_u32_u24 v3, v6, 12, v3
    v_max_i32 v2, 0, v2
    v_mov_b32 v7, 512
    v_cmp_lt_u32 vcc, 0, v2
    v_mov_b32 v6, 4
    s_and_saveexec_b64 s[36:37], vcc
    ds_write_b32 v7, v6
    s_mov_b64 exec, -1
    s_mov_b32 s11, 0x200001fc
    v_and_b32 v58, 15, v0
    v_lshrrev_b32 v28, 4, v0
    v_lshlrev_b32 v28, 5, v28
    v_and_b32 v29, 12, v0
    v_add_u32 v29, v28, v29
    s_mov_b32 s10, 536897024
    v_lshl_add_u32 v30, v29, 1, s10
    v_lshl_or_b32 v30, v0, 30, v30
    v_lshlrev_b32 v58, 5, v58
    s_waitcnt vmcnt(5)
    v_bitop3_b32 v88, v66, s11, v166 bitop3:0x6a
    ds_add_rtn_u32 v67, v88, v6
    s_waitcnt vmcnt(4)
    v_bitop3_b32 v89, v70, s11, v166 bitop3:0x6a
    ds_add_rtn_u32 v71, v89, v6
    s_waitcnt vmcnt(3)
    v_bitop3_b32 v90, v74, s11, v166 bitop3:0x6a
    ds_add_rtn_u32 v75, v90, v6
    s_waitcnt vmcnt(2)
    v_bitop3_b32 v91, v78, s11, v166 bitop3:0x6a
    ds_add_rtn_u32 v79, v91, v6
    s_waitcnt vmcnt(1)
    v_bitop3_b32 v92, v82, s11, v166 bitop3:0x6a
    ds_add_rtn_u32 v83, v92, v6
    s_waitcnt vmcnt(0)
    v_bitop3_b32 v93, v86, s11, v166 bitop3:0x6a
    ds_add_rtn_u32 v87, v93, v6
    s_cmp_eq_u32 s32, 0
    s_cbranch_scc1 L_no8a
    v_bitop3_b32 v12, v10, s11, v166 bitop3:0x6a
    ds_add_rtn_u32 v11, v12, v6
L_no8a:
    s_waitcnt lgkmcnt(0)
    s_barrier
    ds_read_b128 v[44:47], v58
    ds_read_b128 v[48:51], v58 offset:16
    ds_read_b32 v43, v7
    s_lshr_b32 s10, s2, 3
    s_lshl_b32 s33, s3, 5
    s_add_u32 s10, s10, s33
    s_mul_i32 s10, s10, 2048
    v_lshlrev_b32 v20, 7, v0
    s_lshr_b32 s33, s69, 5
    s_sub_u32 s33, 8, s33
    s_and_b32 s33, s33, 7
    s_mul_i32 s33, s33, 640000
    s_add_u32 s10, s10, s33
    s_bfm_b64 exec, 16, 0
    buffer_load_dword v21, v20, s[12:15], s10 offen
    s_mov_b64 exec, -1
    s_mov_b32 s10, 26112
    s_waitcnt lgkmcnt(2)
    v_add_u32 v52, -4, v44
    v_add3_u32 v53, v52, v45, -4
    v_add3_u32 v54, v53, v46, -4
    v_add3_u32 v55, v54, v47, -4
    s_waitcnt lgkmcnt(1)
    v_add3_u32 v56, v55, v48, -4
    v_add3_u32 v57, v56, v49, -4
    v_add3_u32 v60, v57, v50, -4
    v_add3_u32 v61, v60, v51, 28
    v_add_u32 v62, 0x7f, v61
    v_and_b32 v62, 0xffffff80, v62
    v_mov_b32 v63, v62
    v_lshlrev_b32 v42, 2, v0
    s_waitcnt lgkmcnt(0)
    v_add_u32_dpp v63, v63, v63 row_shr:1 row_mask:0xf bank_mask:0xf
    v_readlane_b32 s29, v61, s3
    v_readlane_b32 s30, v62, s3
    v_add_u32_dpp v63, v63, v63 row_shr:2 row_mask:0xf bank_mask:0xf
    v_readfirstlane_b32 s35, v43
    v_add_u32 v42, s29, v42
    v_add_u32_dpp v63, v63, v63 row_shr:4 row_mask:0xf bank_mask:0xf
    v_cmp_gt_u32 vcc, s30, v42
    v_mov_b32 v43, 0x800000
    v_add_u32_dpp v63, v63, v63 row_shr:8 row_mask:0xf bank_mask:0xf
    v_sub_u32 v63, v63, v62
    v_sub_u32 v44, v63, v58
    v_readlane_b32 s28, v63, s3
    v_add_u32 v45, v44, v52
    v_add_u32 v46, v44, v53
    v_add_u32 v47, v44, v54
    v_add_u32 v48, v44, v55
    v_add_u32 v49, v44, v56
    v_add_u32 v50, v44, v57
    v_add_u32 v51, v44, v60
    v_add_u32 v42, s28, v42
    s_mov_b64 exec, 0xfff
    ds_write_b128 v58, v[44:47] offset:576
    ds_write_b128 v58, v[48:51] offset:592
    s_mov_b64 exec, vcc
    ds_write_b32 v42, v43 offset:2048
    s_mov_b64 exec, -1
    s_waitcnt lgkmcnt(0)
    ds_read_b32 v35, v88 offset:576
    ds_read_b32 v36, v89 offset:576
    ds_read_b32 v37, v90 offset:576
    ds_read_b32 v38, v91 offset:576
    ds_read_b32 v39, v92 offset:576
    ds_read_b32 v40, v93 offset:576
    s_sub_u32 s34, s30, s29
    s_lshr_b32 s34, s34, 6
    s_lshr_b32 s30, s30, 7
    s_cmp_lt_u32 s30, 2
    s_cselect_b32 s34, 0, s34
    s_add_u32 s29, s28, 2048
    s_lshl_b32 s28, s28, 1
    v_add_u32 v6, s29, v28
    v_add_u32 v7, s29, v29
    v_add_u32 v30, s28, v30
    s_waitcnt lgkmcnt(5)
    v_add3_u32 v35, v35, v67, v88
    v_lshl_add_u32 v88, v35, 1, s10
    ds_write_b32 v35, v66 offset:2048
    s_waitcnt lgkmcnt(5)
    v_add3_u32 v36, v36, v71, v89
    v_lshl_add_u32 v89, v36, 1, s10
    ds_write_b32 v36, v70 offset:2048
    s_waitcnt lgkmcnt(5)
    v_add3_u32 v37, v37, v75, v90
    v_lshl_add_u32 v90, v37, 1, s10
    ds_write_b32 v37, v74 offset:2048
    s_waitcnt lgkmcnt(5)
    v_add3_u32 v38, v38, v79, v91
    v_lshl_add_u32 v91, v38, 1, s10
    ds_write_b32 v38, v78 offset:2048
    s_waitcnt lgkmcnt(5)
    v_add3_u32 v39, v39, v83, v92
    v_lshl_add_u32 v92, v39, 1, s10
    ds_write_b32 v39, v82 offset:2048
    s_waitcnt lgkmcnt(5)
    v_add3_u32 v40, v40, v87, v93
    v_lshl_add_u32 v93, v40, 1, s10
    ds_write_b32 v40, v86 offset:2048
    s_cmp_eq_u32 s32, 0
    s_cbranch_scc1 L_no8b
    ds_read_b32 v13, v12 offset:576
    s_waitcnt lgkmcnt(0)
    v_add3_u32 v13, v13, v11, v12
    v_lshl_add_u32 v12, v13, 1, s10
    ds_write_b32 v13, v10 offset:2048
    ds_write_b64 v12, v[8:9]
L_no8b:
    s_mov_b32 s31, 2
    s_mov_b32 s28, 0x00fffe00
    s_mov_b32 s29, 0xe0000000
    s_mov_b32 s38, 0x05040100
    s_mov_b32 s39, 0x07060302
    s_mov_b32 s37, 0
    s_waitcnt lgkmcnt(0)
    s_barrier
    s_cmp_lg_u32 s30, 0
    s_cbranch_scc1 L_go
    ds_write_b64 v88, v[64:65]
    ds_write_b64 v89, v[68:69]
    ds_write_b64 v90, v[72:73]
    ds_write_b64 v91, v[76:77]
    ds_write_b64 v92, v[80:81]
    ds_write_b64 v93, v[84:85]
    s_waitcnt lgkmcnt(0)
    s_barrier
    s_branch L_done
L_go:
    ds_read_b128 v[8:11], v6
    ds_read_b128 v[12:15], v6 offset:16
    ds_read2_b32 v[28:29], v7 offset0:0 offset1:4
    v_add_u32 v6, 128, v6
    v_add_u32 v7, 128, v7
    s_waitcnt lgkmcnt(0)
    v_and_or_b32 v8, v8, s28, v1
    v_and_or_b32 v9, v9, s28, v1
    v_and_or_b32 v10, v10, s28, v1
    v_and_or_b32 v11, v11, s28, v1
    v_and_or_b32 v12, v12, s28, v1
    v_and_or_b32 v13, v13, s28, v1
    v_and_or_b32 v14, v14, s28, v1
    v_and_or_b32 v15, v15, s28, v1
    v_bitop3_b32 v28, v28, s29, v30 bitop3:0x6a
    v_bitop3_b32 v29, v29, s29, v30 bitop3:0x6a
    v_add_u32 v30, 256, v30
    buffer_load_dwordx4 v[32:35], v8, s[12:15], 0 offen offset:0
    buffer_load_dwordx4 v[36:39], v9, s[12:15], 0 offen offset:0
    buffer_load_dwordx4 v[40:43], v10, s[12:15], 0 offen offset:0
    buffer_load_dwordx4 v[44:47], v11, s[12:15], 0 offen offset:0
    buffer_load_dwordx4 v[48:51], v12, s[12:15], 0 offen offset:0
    buffer_load_dwordx4 v[52:55], v13, s[12:15], 0 offen offset:0
    buffer_load_dwordx4 v[56:59], v14, s[12:15], 0 offen offset:0
    buffer_load_dwordx4 v[60:63], v15, s[12:15], 0 offen offset:0
    ds_write_b64 v88, v[64:65]
    ds_write_b64 v89, v[68:69]
    ds_write_b64 v90, v[72:73]
    ds_write_b64 v91, v[76:77]
    ds_write_b64 v92, v[80:81]
    ds_write_b64 v93, v[84:85]
    s_waitcnt lgkmcnt(0)
    s_barrier
    buffer_load_dwordx4 v[64:67], v8, s[12:15], 0 offen offset:256
    buffer_load_dwordx4 v[68:71], v9, s[12:15], 0 offen offset:256
    buffer_load_dwordx4 v[72:75], v10, s[12:15], 0 offen offset:256
    buffer_load_dwordx4 v[76:79], v11, s[12:15], 0 offen offset:256
    buffer_load_dwordx4 v[80:83], v12, s[12:15], 0 offen offset:256
    buffer_load_dwordx4 v[84:87], v13, s[12:15], 0 offen offset:256
    buffer_load_dwordx4 v[88:91], v14, s[12:15], 0 offen offset:256
    buffer_load_dwordx4 v[92:95], v15, s[12:15], 0 offen offset:256
    ds_read_b64_tr_b16 v[16:17], v28
    ds_read_b64_tr_b16 v[18:19], v29 offset:32
    ds_read_b128 v[8:11], v6
    ds_read_b128 v[12:15], v6 offset:16
    ds_read2_b32 v[28:29], v7 offset0:0 offset1:4
    v_add_u32 v6, 128, v6
    v_add_u32 v7, 128, v7
    s_sub_u32 s30, s30, s34
    s_sub_u32 s30, s30, 1
    s_cmp_eq_u32 s30, 0
    s_cbranch_scc1 L_tail
L_loop:
    s_waitcnt lgkmcnt(0)
    v_and_or_b32 v8, v8, s28, v1
    v_and_or_b32 v9, v9, s28, v1
    v_and_or_b32 v10, v10, s28, v1
    v_and_or_b32 v11, v11, s28, v1
    v_and_or_b32 v12, v12, s28, v1
    v_and_or_b32 v13, v13, s28, v1
    v_and_or_b32 v14, v14, s28, v1
    v_and_or_b32 v15, v15, s28, v1
    v_bitop3_b32 v28, v28, s29, v30 bitop3:0x6a
    v_bitop3_b32 v29, v29, s29, v30 bitop3:0x6a
    v_add_u32 v30, 256, v30
    s_waitcnt vmcnt(8)
    v_perm_b32 v20, v36, v32, s38
    v_perm_b32 v21, v44, v40, s38
    v_perm_b32 v22, v52, v48, s38
    v_perm_b32 v23, v60, v56, s38
    v_perm_b32 v24, v36, v32, s39
    v_perm_b32 v25, v44, v40, s39
    v_perm_b32 v26, v52, v48, s39
    v_perm_b32 v27, v60, v56, s39
    v_mfma_f32_16x16x32_bf16 v[96:99], v[20:23], v[16:19], v[96:99]
    v_perm_b32 v20, v37, v33, s38
    v_perm_b32 v21, v45, v41, s38
    v_perm_b32 v22, v53, v49, s38
    v_perm_b32 v23, v61, v57, s38
    v_mfma_f32_16x16x32_bf16 v[100:103], v[24:27], v[16:19], v[100:103]
    v_perm_b32 v24, v37, v33, s39
    v_perm_b32 v25, v45, v41, s39
    v_perm_b32 v26, v53, v49, s39
    v_perm_b32 v27, v61, v57, s39
    v_mfma_f32_16x16x32_bf16 v[104:107], v[20:23], v[16:19], v[104:107]
    v_perm_b32 v20, v38, v34, s38
    v_perm_b32 v21, v46, v42, s38
    v_perm_b32 v22, v54, v50, s38
    v_perm_b32 v23, v62, v58, s38
    v_mfma_f32_16x16x32_bf16 v[108:111], v[24:27], v[16:19], v[108:111]
    v_perm_b32 v24, v38, v34, s39
    v_perm_b32 v25, v46, v42, s39
    v_perm_b32 v26, v54, v50, s39
    v_perm_b32 v27, v62, v58, s39
    v_mfma_f32_16x16x32_bf16 v[112:115], v[20:23], v[16:19], v[112:115]
    v_perm_b32 v20, v39, v35, s38
    v_perm_b32 v21, v47, v43, s38
    v_perm_b32 v22, v55, v51, s38
    v_perm_b32 v23, v63, v59, s38
    v_mfma_f32_16x16x32_bf16 v[116:119], v[24:27], v[16:19], v[116:119]
    v_perm_b32 v24, v39, v35, s39
    v_perm_b32 v25, v47, v43, s39
    v_perm_b32 v26, v55, v51, s39
    v_perm_b32 v27, v63, v59, s39
    v_mfma_f32_16x16x32_bf16 v[120:123], v[20:23], v[16:19], v[120:123]
    s_nop 1
    v_mfma_f32_16x16x32_bf16 v[124:127], v[24:27], v[16:19], v[124:127]
    buffer_load_dwordx4 v[32:35], v8, s[12:15], 0 offen offset:0
    buffer_load_dwordx4 v[36:39], v9, s[12:15], 0 offen offset:0
    buffer_load_dwordx4 v[40:43], v10, s[12:15], 0 offen offset:0
    buffer_load_dwordx4 v[44:47], v11, s[12:15], 0 offen offset:0
    buffer_load_dwordx4 v[48:51], v12, s[12:15], 0 offen offset:0
    buffer_load_dwordx4 v[52:55], v13, s[12:15], 0 offen offset:0
    buffer_load_dwordx4 v[56:59], v14, s[12:15], 0 offen offset:0
    buffer_load_dwordx4 v[60:63], v15, s[12:15], 0 offen offset:0
    s_bitcmp0_b32 s31, 0
    s_cbranch_scc1 L_nobar
    s_barrier
L_nobar:
    s_lshr_b32 s31, s31, 1
    s_waitcnt vmcnt(8)
    v_perm_b32 v20, v68, v64, s38
    v_perm_b32 v21, v76, v72, s38
    v_perm_b32 v22, v84, v80, s38
    v_perm_b32 v23, v92, v88, s38
    v_perm_b32 v24, v68, v64, s39
    v_perm_b32 v25, v76, v72, s39
    v_perm_b32 v26, v84, v80, s39
    v_perm_b32 v27, v92, v88, s39
    v_mfma_f32_16x16x32_bf16 v[128:131], v[20:23], v[16:19], v[128:131]
    v_perm_b32 v20, v69, v65, s38
    v_perm_b32 v21, v77, v73, s38
    v_perm_b32 v22, v85, v81, s38
    v_perm_b32 v23, v93, v89, s38
    v_mfma_f32_16x16x32_bf16 v[132:135], v[24:27], v[16:19], v[132:135]
    v_perm_b32 v24, v69, v65, s39
    v_perm_b32 v25, v77, v73, s39
    v_perm_b32 v26, v85, v81, s39
    v_perm_b32 v27, v93, v89, s39
    v_mfma_f32_16x16x32_bf16 v[136:139], v[20:23], v[16:19], v[136:139]
    v_perm_b32 v20, v70, v66, s38
    v_perm_b32 v21, v78, v74, s38
    v_perm_b32 v22, v86, v82, s38
    v_perm_b32 v23, v94, v90, s38
    v_mfma_f32_16x16x32_bf16 v[140:143], v[24:27], v[16:19], v[140:143]
    v_perm_b32 v24, v70, v66, s39
    v_perm_b32 v25, v78, v74, s39
    v_perm_b32 v26, v86, v82, s39
    v_perm_b32 v27, v94, v90, s39
    v_mfma_f32_16x16x32_bf16 v[144:147], v[20:23], v[16:19], v[144:147]
    v_perm_b32 v20, v71, v67, s38
    v_perm_b32 v21, v79, v75, s38
    v_perm_b32 v22, v87, v83, s38
    v_perm_b32 v23, v95, v91, s38
    v_mfma_f32_16x16x32_bf16 v[148:151], v[24:27], v[16:19], v[148:151]
    v_perm_b32 v24, v71, v67, s39
    v_perm_b32 v25, v79, v75, s39
    v_perm_b32 v26, v87, v83, s39
    v_perm_b32 v27, v95, v91, s39
    v_mfma_f32_16x16x32_bf16 v[152:155], v[20:23], v[16:19], v[152:155]
    s_nop 1
    v_mfma_f32_16x16x32_bf16 v[156:159], v[24:27], v[16:19], v[156:159]
    buffer_load_dwordx4 v[64:67], v8, s[12:15], 0 offen offset:256
    buffer_load_dwordx4 v[68:71], v9, s[12:15], 0 offen offset:256
    buffer_load_dwordx4 v[72:75], v10, s[12:15], 0 offen offset:256
    buffer_load_dwordx4 v[76:79], v11, s[12:15], 0 offen offset:256
    buffer_load_dwordx4 v[80:83], v12, s[12:15], 0 offen offset:256
    buffer_load_dwordx4 v[84:87], v13, s[12:15], 0 offen offset:256
    buffer_load_dwordx4 v[88:91], v14, s[12:15], 0 offen offset:256
    buffer_load_dwordx4 v[92:95], v15, s[12:15], 0 offen offset:256
    ds_read_b64_tr_b16 v[16:17], v28
    ds_read_b64_tr_b16 v[18:19], v29 offset:32
    ds_read_b128 v[8:11], v6
    ds_read_b128 v[12:15], v6 offset:16
    ds_read2_b32 v[28:29], v7 offset0:0 offset1:4
    v_add_u32 v6, 128, v6
    v_add_u32 v7, 128, v7
    s_sub_u32 s30, s30, 1
    s_cmp_lg_u32 s30, 0
    s_cbranch_scc1 L_loop
L_tail:
    s_cmp_eq_u32 s34, 0
    s_cbranch_scc1 L_last
    v_and_b32 v20, 48, v0
    v_add_u32 v21, 128, v20
    v_sub_u32 v6, v6, v21
    v_sub_u32 v7, v7, v21
    v_lshlrev_b32 v20, 1, v20
    v_sub_u32 v30, v30, v20
    s_waitcnt lgkmcnt(0)
    ds_read_b128 v[8:11], v6
    ds_read_b32 v28, v7
    s_waitcnt vmcnt(8)
    v_perm_b32 v20, v36, v32, s38
    v_perm_b32 v21, v44, v40, s38
    v_perm_b32 v22, v52, v48, s38
    v_perm_b32 v23, v60, v56, s38
    v_perm_b32 v24, v36, v32, s39
    v_perm_b32 v25, v44, v40, s39
    v_perm_b32 v26, v52, v48, s39
    v_perm_b32 v27, v60, v56, s39
    v_mfma_f32_16x16x32_bf16 v[96:99], v[20:23], v[16:19], v[96:99]
    v_perm_b32 v20, v37, v33, s38
    v_perm_b32 v21, v45, v41, s38
    v_perm_b32 v22, v53, v49, s38
    v_perm_b32 v23, v61, v57, s38
    v_mfma_f32_16x16x32_bf16 v[100:103], v[24:27], v[16:19], v[100:103]
    v_perm_b32 v24, v37, v33, s39
    v_perm_b32 v25, v45, v41, s39
    v_perm_b32 v26, v53, v49, s39
    v_perm_b32 v27, v61, v57, s39
    v_mfma_f32_16x16x32_bf16 v[104:107], v[20:23], v[16:19], v[104:107]
    v_perm_b32 v20, v38, v34, s38
    v_perm_b32 v21, v46, v42, s38
    v_perm_b32 v22, v54, v50, s38
    v_perm_b32 v23, v62, v58, s38
    v_mfma_f32_16x16x32_bf16 v[108:111], v[24:27], v[16:19], v[108:111]
    v_perm_b32 v24, v38, v34, s39
    v_perm_b32 v25, v46, v42, s39
    v_perm_b32 v26, v54, v50, s39
    v_perm_b32 v27, v62, v58, s39
    v_mfma_f32_16x16x32_bf16 v[112:115], v[20:23], v[16:19], v[112:115]
    v_perm_b32 v20, v39, v35, s38
    v_perm_b32 v21, v47, v43, s38
    v_perm_b32 v22, v55, v51, s38
    v_perm_b32 v23, v63, v59, s38
    v_mfma_f32_16x16x32_bf16 v[116:119], v[24:27], v[16:19], v[116:119]
    v_perm_b32 v24, v39, v35, s39
    v_perm_b32 v25, v47, v43, s39
    v_perm_b32 v26, v55, v51, s39
    v_perm_b32 v27, v63, v59, s39
    v_mfma_f32_16x16x32_bf16 v[120:123], v[20:23], v[16:19], v[120:123]
    s_nop 1
    v_mfma_f32_16x16x32_bf16 v[124:127], v[24:27], v[16:19], v[124:127]
    s_waitcnt lgkmcnt(0)
    v_and_or_b32 v8, v8, s28, v1
    v_and_or_b32 v9, v9, s28, v1
    v_and_or_b32 v10, v10, s28, v1
    v_and_or_b32 v11, v11, s28, v1
    v_bitop3_b32 v28, v28, s29, v30 bitop3:0x6a
    buffer_load_dwordx4 v[32:35], v8, s[12:15], 0 offen offset:0
    buffer_load_dwordx4 v[36:39], v9, s[12:15], 0 offen offset:0
    buffer_load_dwordx4 v[40:43], v10, s[12:15], 0 offen offset:0
    buffer_load_dwordx4 v[44:47], v11, s[12:15], 0 offen offset:0
    s_bitcmp0_b32 s31, 0
    s_cbranch_scc1 L_nobar2
    s_barrier
L_nobar2:
    s_lshr_b32 s31, s31, 1
    s_waitcnt vmcnt(4)
    v_perm_b32 v20, v68, v64, s38
    v_perm_b32 v21, v76, v72, s38
    v_perm_b32 v22, v84, v80, s38
    v_perm_b32 v23, v92, v88, s38
    v_perm_b32 v24, v68, v64, s39
    v_perm_b32 v25, v76, v72, s39
    v_perm_b32 v26, v84, v80, s39
    v_perm_b32 v27, v92, v88, s39
    v_mfma_f32_16x16x32_bf16 v[128:131], v[20:23], v[16:19], v[128:131]
    v_perm_b32 v20, v69, v65, s38
    v_perm_b32 v21, v77, v73, s38
    v_perm_b32 v22, v85, v81, s38
    v_perm_b32 v23, v93, v89, s38
    v_mfma_f32_16x16x32_bf16 v[132:135], v[24:27], v[16:19], v[132:135]
    v_perm_b32 v24, v69, v65, s39
    v_perm_b32 v25, v77, v73, s39
    v_perm_b32 v26, v85, v81, s39
    v_perm_b32 v27, v93, v89, s39
    v_mfma_f32_16x16x32_bf16 v[136:139], v[20:23], v[16:19], v[136:139]
    v_perm_b32 v20, v70, v66, s38
    v_perm_b32 v21, v78, v74, s38
    v_perm_b32 v22, v86, v82, s38
    v_perm_b32 v23, v94, v90, s38
    v_mfma_f32_16x16x32_bf16 v[140:143], v[24:27], v[16:19], v[140:143]
    v_perm_b32 v24, v70, v66, s39
    v_perm_b32 v25, v78, v74, s39
    v_perm_b32 v26, v86, v82, s39
    v_perm_b32 v27, v94, v90, s39
    v_mfma_f32_16x16x32_bf16 v[144:147], v[20:23], v[16:19], v[144:147]
    v_perm_b32 v20, v71, v67, s38
    v_perm_b32 v21, v79, v75, s38
    v_perm_b32 v22, v87, v83, s38
    v_perm_b32 v23, v95, v91, s38
    v_mfma_f32_16x16x32_bf16 v[148:151], v[24:27], v[16:19], v[148:151]
    v_perm_b32 v24, v71, v67, s39
    v_perm_b32 v25, v79, v75, s39
    v_perm_b32 v26, v87, v83, s39
    v_perm_b32 v27, v95, v91, s39
    v_mfma_f32_16x16x32_bf16 v[152:155], v[20:23], v[16:19], v[152:155]
    s_nop 1
    v_mfma_f32_16x16x32_bf16 v[156:159], v[24:27], v[16:19], v[156:159]
    buffer_load_dwordx4 v[64:67], v8, s[12:15], 0 offen offset:256
    buffer_load_dwordx4 v[68:71], v9, s[12:15], 0 offen offset:256
    buffer_load_dwordx4 v[72:75], v10, s[12:15], 0 offen offset:256
    buffer_load_dwordx4 v[76:79], v11, s[12:15], 0 offen offset:256
    ds_read_b64_tr_b16 v[16:17], v28
    s_waitcnt vmcnt(4) lgkmcnt(0)
    v_perm_b32 v20, v36, v32, s38
    v_perm_b32 v21, v44, v40, s38
    v_perm_b32 v24, v36, v32, s39
    v_perm_b32 v25, v44, v40, s39
    v_mfma_f32_16x16x16_bf16 v[96:99], v[20:21], v[16:17], v[96:99]
    v_perm_b32 v20, v37, v33, s38
    v_perm_b32 v21, v45, v41, s38
    v_mfma_f32_16x16x16_bf16 v[100:103], v[24:25], v[16:17], v[100:103]
    v_perm_b32 v24, v37, v33, s39
    v_perm_b32 v25, v45, v41, s39
    v_mfma_f32_16x16x16_bf16 v[104:107], v[20:21], v[16:17], v[104:107]
    v_perm_b32 v20, v38, v34, s38
    v_perm_b32 v21, v46, v42, s38
    v_mfma_f32_16x16x16_bf16 v[108:111], v[24:25], v[16:17], v[108:111]
    v_perm_b32 v24, v38, v34, s39
    v_perm_b32 v25, v46, v42, s39
    v_mfma_f32_16x16x16_bf16 v[112:115], v[20:21], v[16:17], v[112:115]
    v_perm_b32 v20, v39, v35, s38
    v_perm_b32 v21, v47, v43, s38
    v_mfma_f32_16x16x16_bf16 v[116:119], v[24:25], v[16:17], v[116:119]
    v_perm_b32 v24, v39, v35, s39
    v_perm_b32 v25, v47, v43, s39
    v_mfma_f32_16x16x16_bf16 v[120:123], v[20:21], v[16:17], v[120:123]
    s_nop 1
    v_mfma_f32_16x16x16_bf16 v[124:127], v[24:25], v[16:17], v[124:127]
    s_waitcnt vmcnt(0)
    v_perm_b32 v20, v68, v64, s38
    v_perm_b32 v21, v76, v72, s38
    v_perm_b32 v24, v68, v64, s39
    v_perm_b32 v25, v76, v72, s39
    v_mfma_f32_16x16x16_bf16 v[128:131], v[20:21], v[16:17], v[128:131]
    v_perm_b32 v20, v69, v65, s38
    v_perm_b32 v21, v77, v73, s38
    v_mfma_f32_16x16x16_bf16 v[132:135], v[24:25], v[16:17], v[132:135]
    v_perm_b32 v24, v69, v65, s39
    v_perm_b32 v25, v77, v73, s39
    v_mfma_f32_16x16x16_bf16 v[136:139], v[20:21], v[16:17], v[136:139]
    v_perm_b32 v20, v70, v66, s38
    v_perm_b32 v21, v78, v74, s38
    v_mfma_f32_16x16x16_bf16 v[140:143], v[24:25], v[16:17], v[140:143]
    v_perm_b32 v24, v70, v66, s39
    v_perm_b32 v25, v78, v74, s39
    v_mfma_f32_16x16x16_bf16 v[144:147], v[20:21], v[16:17], v[144:147]
    v_perm_b32 v20, v71, v67, s38
    v_perm_b32 v21, v79, v75, s38
    v_mfma_f32_16x16x16_bf16 v[148:151], v[24:25], v[16:17], v[148:151]
    v_perm_b32 v24, v71, v67, s39
    v_perm_b32 v25, v79, v75, s39
    v_mfma_f32_16x16x16_bf16 v[152:155], v[20:21], v[16:17], v[152:155]
    s_nop 1
    v_mfma_f32_16x16x16_bf16 v[156:159], v[24:25], v[16:17], v[156:159]
    s_branch L_done
L_last:
    s_waitcnt vmcnt(8) lgkmcnt(0)
    v_perm_b32 v20, v36, v32, s38
    v_perm_b32 v21, v44, v40, s38
    v_perm_b32 v22, v52, v48, s38
    v_perm_b32 v23, v60, v56, s38
    v_perm_b32 v24, v36, v32, s39
    v_perm_b32 v25, v44, v40, s39
    v_perm_b32 v26, v52, v48, s39
    v_perm_b32 v27, v60, v56, s39
    v_mfma_f32_16x16x32_bf16 v[96:99], v[20:23], v[16:19], v[96:99]
    v_perm_b32 v20, v37, v33, s38
    v_perm_b32 v21, v45, v41, s38
    v_perm_b32 v22, v53, v49, s38
    v_perm_b32 v23, v61, v57, s38
    v_mfma_f32_16x16x32_bf16 v[100:103], v[24:27], v[16:19], v[100:103]
    v_perm_b32 v24, v37, v33, s39
    v_perm_b32 v25, v45, v41, s39
    v_perm_b32 v26, v53, v49, s39
    v_perm_b32 v27, v61, v57, s39
    v_mfma_f32_16x16x32_bf16 v[104:107], v[20:23], v[16:19], v[104:107]
    v_perm_b32 v20, v38, v34, s38
    v_perm_b32 v21, v46, v42, s38
    v_perm_b32 v22, v54, v50, s38
    v_perm_b32 v23, v62, v58, s38
    v_mfma_f32_16x16x32_bf16 v[108:111], v[24:27], v[16:19], v[108:111]
    v_perm_b32 v24, v38, v34, s39
    v_perm_b32 v25, v46, v42, s39
    v_perm_b32 v26, v54, v50, s39
    v_perm_b32 v27, v62, v58, s39
    v_mfma_f32_16x16x32_bf16 v[112:115], v[20:23], v[16:19], v[112:115]
    v_perm_b32 v20, v39, v35, s38
    v_perm_b32 v21, v47, v43, s38
    v_perm_b32 v22, v55, v51, s38
    v_perm_b32 v23, v63, v59, s38
    v_mfma_f32_16x16x32_bf16 v[116:119], v[24:27], v[16:19], v[116:119]
    v_perm_b32 v24, v39, v35, s39
    v_perm_b32 v25, v47, v43, s39
    v_perm_b32 v26, v55, v51, s39
    v_perm_b32 v27, v63, v59, s39
    v_mfma_f32_16x16x32_bf16 v[120:123], v[20:23], v[16:19], v[120:123]
    s_nop 1
    v_mfma_f32_16x16x32_bf16 v[124:127], v[24:27], v[16:19], v[124:127]
    s_waitcnt vmcnt(0)
    v_perm_b32 v20, v68, v64, s38
    v_perm_b32 v21, v76, v72, s38
    v_perm_b32 v22, v84, v80, s38
    v_perm_b32 v23, v92, v88, s38
    v_perm_b32 v24, v68, v64, s39
    v_perm_b32 v25, v76, v72, s39
    v_perm_b32 v26, v84, v80, s39
    v_perm_b32 v27, v92, v88, s39
    v_mfma_f32_16x16x32_bf16 v[128:131], v[20:23], v[16:19], v[128:131]
    v_perm_b32 v20, v69, v65, s38
    v_perm_b32 v21, v77, v73, s38
    v_perm_b32 v22, v85, v81, s38
    v_perm_b32 v23, v93, v89, s38
    v_mfma_f32_16x16x32_bf16 v[132:135], v[24:27], v[16:19], v[132:135]
    v_perm_b32 v24, v69, v65, s39
    v_perm_b32 v25, v77, v73, s39
    v_perm_b32 v26, v85, v81, s39
    v_perm_b32 v27, v93, v89, s39
    v_mfma_f32_16x16x32_bf16 v[136:139], v[20:23], v[16:19], v[136:139]
    v_perm_b32 v20, v70, v66, s38
    v_perm_b32 v21, v78, v74, s38
    v_perm_b32 v22, v86, v82, s38
    v_perm_b32 v23, v94, v90, s38
    v_mfma_f32_16x16x32_bf16 v[140:143], v[24:27], v[16:19], v[140:143]
    v_perm_b32 v24, v70, v66, s39
    v_perm_b32 v25, v78, v74, s39
    v_perm_b32 v26, v86, v82, s39
    v_perm_b32 v27, v94, v90, s39
    v_mfma_f32_16x16x32_bf16 v[144:147], v[20:23], v[16:19], v[144:147]
    v_perm_b32 v20, v71, v67, s38
    v_perm_b32 v21, v79, v75, s38
    v_perm_b32 v22, v87, v83, s38
    v_perm_b32 v23, v95, v91, s38
    v_mfma_f32_16x16x32_bf16 v[148:151], v[24:27], v[16:19], v[148:151]
    v_perm_b32 v24, v71, v67, s39
    v_perm_b32 v25, v79, v75, s39
    v_perm_b32 v26, v87, v83, s39
    v_perm_b32 v27, v95, v91, s39
    v_mfma_f32_16x16x32_bf16 v[152:155], v[20:23], v[16:19], v[152:155]
    s_nop 1
    v_mfma_f32_16x16x32_bf16 v[156:159], v[24:27], v[16:19], v[156:159]
L_done:
    s_ff1_i32_b32 s30, s31
    s_cmp_eq_u32 s31, 0
    s_cbranch_scc1 L_paid
    s_bitset0_b32 s31, s30
    s_barrier
    s_branch L_done
L_paid:
    s_waitcnt vmcnt(0)
    s_cmp_eq_u32 s35, 0
    s_cbranch_scc1 L_epi
    s_barrier
    v_mov_b32 v6, 0
    v_lshlrev_b32 v7, 2, v0
    ds_write_b32 v7, v6
    ds_write_b32 v7, v6 offset:256
    ds_write_b32 v7, v6 offset:264
    s_waitcnt lgkmcnt(0)
    s_barrier
    s_branch L_round
L_epi:
    s_mov_b32 s10, 74240
    v_lshl_add_u32 v1, v0, 4, s10
    ds_read_b128 v[64:67], v1 offset:0
    ds_read_b128 v[68:71], v1 offset:1024
    ds_read_b128 v[72:75], v1 offset:2048
    ds_read_b128 v[76:79], v1 offset:3072
    ds_read_b128 v[80:83], v1 offset:4096
    ds_read_b128 v[84:87], v1 offset:5120
    ds_read_b128 v[88:91], v1 offset:6144
    ds_read_b128 v[92:95], v1 offset:7168
    v_permlane32_swap_b32 v96, v112
    s_mul_i32 s10, s69, 625
    v_permlane32_swap_b32 v97, v113
    s_add_u32 s28, s10, 640
    v_permlane32_swap_b32 v98, v114
    s_add_u32 s10, s10, 15
    v_permlane32_swap_b32 v99, v115
    s_lshr_b32 s10, s10, 4
    v_permlane32_swap_b32 v100, v116
    s_lshr_b32 s28, s28, 4
    v_permlane32_swap_b32 v101, v117
    s_mul_i32 s11, s3, 10
    v_permlane32_swap_b32 v102, v118
    s_add_u32 s29, s11, 12
    v_permlane32_swap_b32 v103, v119
    s_add_u32 s11, s11, 2
    v_permlane32_swap_b32 v104, v120
    s_mul_i32 s11, s11, 43691
    v_permlane32_swap_b32 v105, v121
    s_mul_i32 s29, s29, 43691
    v_permlane32_swap_b32 v106, v122
    s_lshr_b32 s11, s11, 17
    v_permlane32_swap_b32 v107, v123
    s_lshr_b32 s29, s29, 17
    v_permlane32_swap_b32 v108, v124
    s_add_u32 s29, s29, s10
    v_permlane32_swap_b32 v109, v125
    s_add_u32 s10, s10, s11
    v_permlane32_swap_b32 v110, v126
    s_min_u32 s28, s28, s29
    v_permlane32_swap_b32 v111, v127
    s_sub_u32 s28, s28, s10
    v_cvt_pk_bf16_f32 v8, v96, v100
    v_cvt_pk_bf16_f32 v9, v104, v108
    v_cvt_pk_bf16_f32 v10, v97, v101
    v_cvt_pk_bf16_f32 v11, v105, v109
    v_cvt_pk_bf16_f32 v12, v98, v102
    v_cvt_pk_bf16_f32 v13, v106, v110
    v_cvt_pk_bf16_f32 v14, v99, v103
    v_cvt_pk_bf16_f32 v15, v107, v111
    v_permlane32_swap_b32 v128, v144
    v_permlane32_swap_b32 v129, v145
    s_waitcnt lgkmcnt(4)
    v_mfma_f32_16x16x32_bf16 v[32:35], v[8:11], v[64:67], 0
    ds_read_b128 v[64:67], v1 offset:16384
    v_permlane32_swap_b32 v130, v146
    v_permlane32_swap_b32 v131, v147
    v_mfma_f32_16x16x32_bf16 v[36:39], v[8:11], v[68:71], 0
    ds_read_b128 v[68:71], v1 offset:17408
    v_permlane32_swap_b32 v132, v148
    v_permlane32_swap_b32 v133, v149
    v_permlane32_swap_b32 v134, v150
    v_mfma_f32_16x16x32_bf16 v[40:43], v[8:11], v[72:75], 0
    ds_read_b128 v[72:75], v1 offset:18432
    v_permlane32_swap_b32 v135, v151
    v_permlane32_swap_b32 v136, v152
    v_mfma_f32_16x16x32_bf16 v[44:47], v[8:11], v[76:79], 0
    ds_read_b128 v[76:79], v1 offset:19456
    v_permlane32_swap_b32 v137, v153
    v_permlane32_swap_b32 v138, v154
    v_permlane32_swap_b32 v139, v155
    s_waitcnt lgkmcnt(4)
    v_mfma_f32_16x16x32_bf16 v[32:35], v[12:15], v[80:83], v[32:35]
    ds_read_b128 v[80:83], v1 offset:20480
    v_permlane32_swap_b32 v140, v156
    v_permlane32_swap_b32 v141, v157
    v_permlane32_swap_b32 v142, v158
    v_mfma_f32_16x16x32_bf16 v[36:39], v[12:15], v[84:87], v[36:39]
    ds_read_b128 v[84:87], v1 offset:21504
    v_permlane32_swap_b32 v143, v159
    v_mul_f32_dpp v2, v112, v160 quad_perm:[1,0,3,2] row_mask:0xf bank_mask:0xf
    v_mfma_f32_16x16x32_bf16 v[40:43], v[12:15], v[88:91], v[40:43]
    ds_read_b128 v[88:91], v1 offset:22528
    v_mul_f32_dpp v3, v116, v160 quad_perm:[1,0,3,2] row_mask:0xf bank_mask:0xf
    v_fmac_f32_dpp v2, v128, v161 quad_perm:[2,3,0,1] row_mask:0xf bank_mask:0xf
    v_fmac_f32_dpp v3, v132, v161 quad_perm:[2,3,0,1] row_mask:0xf bank_mask:0xf
    v_mfma_f32_16x16x32_bf16 v[44:47], v[12:15], v[92:95], v[44:47]
    ds_read_b128 v[92:95], v1 offset:23552
    v_fmac_f32_dpp v2, v144, v162 quad_perm:[3,2,1,0] row_mask:0xf bank_mask:0xf
    v_fmac_f32_dpp v3, v148, v162 quad_perm:[3,2,1,0] row_mask:0xf bank_mask:0xf
    v_cvt_pk_bf16_f32 v16, v2, v3
    s_waitcnt lgkmcnt(4)
    v_mfma_f32_16x16x32_bf16 v[48:51], v[8:11], v[64:67], 0
    ds_read_b128 v[64:67], v1 offset:8192
    v_mul_f32_dpp v4, v120, v160 quad_perm:[1,0,3,2] row_mask:0xf bank_mask:0xf
    v_mul_f32_dpp v5, v124, v160 quad_perm:[1,0,3,2] row_mask:0xf bank_mask:0xf
    v_mfma_f32_16x16x32_bf16 v[52:55], v[8:11], v[68:71], 0
    ds_read_b128 v[68:71], v1 offset:9216
    v_fmac_f32_dpp v4, v136, v161 quad_perm:[2,3,0,1] row_mask:0xf bank_mask:0xf
    v_fmac_f32_dpp v5, v140, v161 quad_perm:[2,3,0,1] row_mask:0xf bank_mask:0xf
    v_fmac_f32_dpp v4, v152, v162 quad_perm:[3,2,1,0] row_mask:0xf bank_mask:0xf
    v_mfma_f32_16x16x32_bf16 v[56:59], v[8:11], v[72:75], 0
    ds_read_b128 v[72:75], v1 offset:10240
    v_fmac_f32_dpp v5, v156, v162 quad_perm:[3,2,1,0] row_mask:0xf bank_mask:0xf
    v_cvt_pk_bf16_f32 v17, v4, v5
    v_mfma_f32_16x16x32_bf16 v[60:63], v[8:11], v[76:79], 0
    ds_read_b128 v[76:79], v1 offset:11264
    v_mul_f32_dpp v2, v113, v160 quad_perm:[1,0,3,2] row_mask:0xf bank_mask:0xf
    v_mul_f32_dpp v3, v117, v160 quad_perm:[1,0,3,2] row_mask:0xf bank_mask:0xf
    v_fmac_f32_dpp v2, v129, v161 quad_perm:[2,3,0,1] row_mask:0xf bank_mask:0xf
    s_waitcnt lgkmcnt(4)
    v_mfma_f32_16x16x32_bf16 v[48:51], v[12:15], v[80:83], v[48:51]
    ds_read_b128 v[80:83], v1 offset:24576
    v_fmac_f32_dpp v3, v133, v161 quad_perm:[2,3,0,1] row_mask:0xf bank_mask:0xf
    v_fmac_f32_dpp v2, v145, v162 quad_perm:[3,2,1,0] row_mask:0xf bank_mask:0xf
    v_fmac_f32_dpp v3, v149, v162 quad_perm:[3,2,1,0] row_mask:0xf bank_mask:0xf
    v_mfma_f32_16x16x32_bf16 v[52:55], v[12:15], v[84:87], v[52:55]
    ds_read_b128 v[84:87], v1 offset:25600
    v_cvt_pk_bf16_f32 v18, v2, v3
    v_mul_f32_dpp v4, v121, v160 quad_perm:[1,0,3,2] row_mask:0xf bank_mask:0xf
    v_mfma_f32_16x16x32_bf16 v[56:59], v[12:15], v[88:91], v[56:59]
    ds_read_b128 v[88:91], v1 offset:26624
    v_mul_f32_dpp v5, v125, v160 quad_perm:[1,0,3,2] row_mask:0xf bank_mask:0xf
    v_fmac_f32_dpp v4, v137, v161 quad_perm:[2,3,0,1] row_mask:0xf bank_mask:0xf
    v_fmac_f32_dpp v5, v141, v161 quad_perm:[2,3,0,1] row_mask:0xf bank_mask:0xf
    v_mfma_f32_16x16x32_bf16 v[60:63], v[12:15], v[92:95], v[60:63]
    ds_read_b128 v[92:95], v1 offset:27648
    v_fmac_f32_dpp v4, v153, v162 quad_perm:[3,2,1,0] row_mask:0xf bank_mask:0xf
    v_fmac_f32_dpp v5, v157, v162 quad_perm:[3,2,1,0] row_mask:0xf bank_mask:0xf
    v_cvt_pk_bf16_f32 v19, v4, v5
    v_mul_f32_dpp v2, v114, v160 quad_perm:[1,0,3,2] row_mask:0xf bank_mask:0xf
    v_mul_f32_dpp v3, v118, v160 quad_perm:[1,0,3,2] row_mask:0xf bank_mask:0xf
    s_waitcnt lgkmcnt(4)
    v_mfma_f32_16x16x32_bf16 v[32:35], v[16:19], v[64:67], v[32:35]
    ds_read_b128 v[64:67], v1 offset:12288
    v_fmac_f32_dpp v2, v130, v161 quad_perm:[2,3,0,1] row_mask:0xf bank_mask:0xf
    v_fmac_f32_dpp v3, v134, v161 quad_perm:[2,3,0,1] row_mask:0xf bank_mask:0xf
    v_fmac_f32_dpp v2, v146, v162 quad_perm:[3,2,1,0] row_mask:0xf bank_mask:0xf
    v_mfma_f32_16x16x32_bf16 v[36:39], v[16:19], v[68:71], v[36:39]
    ds_read_b128 v[68:71], v1 offset:13312
    v_fmac_f32_dpp v3, v150, v162 quad_perm:[3,2,1,0] row_mask:0xf bank_mask:0xf
    v_cvt_pk_bf16_f32 v20, v2, v3
    v_mul_f32_dpp v4, v122, v160 quad_perm:[1,0,3,2] row_mask:0xf bank_mask:0xf
    v_mfma_f32_16x16x32_bf16 v[40:43], v[16:19], v[72:75], v[40:43]
    ds_read_b128 v[72:75], v1 offset:14336
    v_mul_f32_dpp v5, v126, v160 quad_perm:[1,0,3,2] row_mask:0xf bank_mask:0xf
    v_fmac_f32_dpp v4, v138, v161 quad_perm:[2,3,0,1] row_mask:0xf bank_mask:0xf
    v_fmac_f32_dpp v5, v142, v161 quad_perm:[2,3,0,1] row_mask:0xf bank_mask:0xf
    v_mfma_f32_16x16x32_bf16 v[44:47], v[16:19], v[76:79], v[44:47]
    ds_read_b128 v[76:79], v1 offset:15360
    v_fmac_f32_dpp v4, v154, v162 quad_perm:[3,2,1,0] row_mask:0xf bank_mask:0xf
    v_fmac_f32_dpp v5, v158, v162 quad_perm:[3,2,1,0] row_mask:0xf bank_mask:0xf
    v_cvt_pk_bf16_f32 v21, v4, v5
    v_mul_f32_dpp v2, v115, v160 quad_perm:[1,0,3,2] row_mask:0xf bank_mask:0xf
    s_waitcnt lgkmcnt(4)
    v_mfma_f32_16x16x32_bf16 v[48:51], v[16:19], v[80:83], v[48:51]
    ds_read_b128 v[80:83], v1 offset:28672
    v_mul_f32_dpp v3, v119, v160 quad_perm:[1,0,3,2] row_mask:0xf bank_mask:0xf
    v_fmac_f32_dpp v2, v131, v161 quad_perm:[2,3,0,1] row_mask:0xf bank_mask:0xf
    v_fmac_f32_dpp v3, v135, v161 quad_perm:[2,3,0,1] row_mask:0xf bank_mask:0xf
    v_mfma_f32_16x16x32_bf16 v[52:55], v[16:19], v[84:87], v[52:55]
    ds_read_b128 v[84:87], v1 offset:29696
    v_fmac_f32_dpp v2, v147, v162 quad_perm:[3,2,1,0] row_mask:0xf bank_mask:0xf
    v_fmac_f32_dpp v3, v151, v162 quad_perm:[3,2,1,0] row_mask:0xf bank_mask:0xf
    v_cvt_pk_bf16_f32 v22, v2, v3
    v_mfma_f32_16x16x32_bf16 v[56:59], v[16:19], v[88:91], v[56:59]
    ds_read_b128 v[88:91], v1 offset:30720
    v_mul_f32_dpp v4, v123, v160 quad_perm:[1,0,3,2] row_mask:0xf bank_mask:0xf
    v_mul_f32_dpp v5, v127, v160 quad_perm:[1,0,3,2] row_mask:0xf bank_mask:0xf
    v_fmac_f32_dpp v4, v139, v161 quad_perm:[2,3,0,1] row_mask:0xf bank_mask:0xf
    v_mfma_f32_16x16x32_bf16 v[60:63], v[16:19], v[92:95], v[60:63]
    ds_read_b128 v[92:95], v1 offset:31744
    v_fmac_f32_dpp v5, v143, v161 quad_perm:[2,3,0,1] row_mask:0xf bank_mask:0xf
    v_fmac_f32_dpp v4, v155, v162 quad_perm:[3,2,1,0] row_mask:0xf bank_mask:0xf
    v_fmac_f32_dpp v5, v159, v162 quad_perm:[3,2,1,0] row_mask:0xf bank_mask:0xf
    v_cvt_pk_bf16_f32 v23, v4, v5
    v_mul_f32_dpp v2, v112, v163 quad_perm:[1,0,3,2] row_mask:0xf bank_mask:0xf
    v_mul_f32_dpp v3, v116, v163 quad_perm:[1,0,3,2] row_mask:0xf bank_mask:0xf
    s_waitcnt lgkmcnt(4)
    v_mfma_f32_16x16x32_bf16 v[32:35], v[20:23], v[64:67], v[32:35]
    ds_read_b128 v[64:67], v1 offset:32768
    v_fmac_f32_dpp v2, v128, v164 quad_perm:[2,3,0,1] row_mask:0xf bank_mask:0xf
    v_fmac_f32_dpp v3, v132, v164 quad_perm:[2,3,0,1] row_mask:0xf bank_mask:0xf
    v_fmac_f32_dpp v2, v144, v165 quad_perm:[3,2,1,0] row_mask:0xf bank_mask:0xf
    v_mfma_f32_16x16x32_bf16 v[36:39], v[20:23], v[68:71], v[36:39]
    ds_read_b128 v[68:71], v1 offset:33792
    v_fmac_f32_dpp v3, v148, v165 quad_perm:[3,2,1,0] row_mask:0xf bank_mask:0xf
    v_cvt_pk_bf16_f32 v24, v2, v3
    v_mul_f32_dpp v4, v120, v163 quad_perm:[1,0,3,2] row_mask:0xf bank_mask:0xf
    v_mfma_f32_16x16x32_bf16 v[40:43], v[20:23], v[72:75], v[40:43]
    ds_read_b128 v[72:75], v1 offset:34816
    v_mul_f32_dpp v5, v124, v163 quad_perm:[1,0,3,2] row_mask:0xf bank_mask:0xf
    v_fmac_f32_dpp v4, v136, v164 quad_perm:[2,3,0,1] row_mask:0xf bank_mask:0xf
    v_fmac_f32_dpp v5, v140, v164 quad_perm:[2,3,0,1] row_mask:0xf bank_mask:0xf
    v_mfma_f32_16x16x32_bf16 v[44:47], v[20:23], v[76:79], v[44:47]
    ds_read_b128 v[76:79], v1 offset:35840
    v_fmac_f32_dpp v4, v152, v165 quad_perm:[3,2,1,0] row_mask:0xf bank_mask:0xf
    v_fmac_f32_dpp v5, v156, v165 quad_perm:[3,2,1,0] row_mask:0xf bank_mask:0xf
    v_cvt_pk_bf16_f32 v25, v4, v5
    v_mul_f32_dpp v2, v113, v163 quad_perm:[1,0,3,2] row_mask:0xf bank_mask:0xf
    s_waitcnt lgkmcnt(4)
    v_mfma_f32_16x16x32_bf16 v[48:51], v[20:23], v[80:83], v[48:51]
    ds_read_b128 v[80:83], v1 offset:36864
    v_mul_f32_dpp v3, v117, v163 quad_perm:[1,0,3,2] row_mask:0xf bank_mask:0xf
    v_fmac_f32_dpp v2, v129, v164 quad_perm:[2,3,0,1] row_mask:0xf bank_mask:0xf
    v_fmac_f32_dpp v3, v133, v164 quad_perm:[2,3,0,1] row_mask:0xf bank_mask:0xf
    v_mfma_f32_16x16x32_bf16 v[52:55], v[20:23], v[84:87], v[52:55]
    ds_read_b128 v[84:87], v1 offset:37888
    v_fmac_f32_dpp v2, v145, v165 quad_perm:[3,2,1,0] row_mask:0xf bank_mask:0xf
    v_fmac_f32_dpp v3, v149, v165 quad_perm:[3,2,1,0] row_mask:0xf bank_mask:0xf
    v_cvt_pk_bf16_f32 v26, v2, v3
    v_mfma_f32_16x16x32_bf16 v[56:59], v[20:23], v[88:91], v[56:59]
    ds_read_b128 v[88:91], v1 offset:38912
    v_mul_f32_dpp v4, v121, v163 quad_perm:[1,0,3,2] row_mask:0xf bank_mask:0xf
    v_mul_f32_dpp v5, v125, v163 quad_perm:[1,0,3,2] row_mask:0xf bank_mask:0xf
    v_fmac_f32_dpp v4, v137, v164 quad_perm:[2,3,0,1] row_mask:0xf bank_mask:0xf
    v_mfma_f32_16x16x32_bf16 v[60:63], v[20:23], v[92:95], v[60:63]
    ds_read_b128 v[92:95], v1 offset:39936
    v_fmac_f32_dpp v5, v141, v164 quad_perm:[2,3,0,1] row_mask:0xf bank_mask:0xf
    v_fmac_f32_dpp v4, v153, v165 quad_perm:[3,2,1,0] row_mask:0xf bank_mask:0xf
    v_fmac_f32_dpp v5, v157, v165 quad_perm:[3,2,1,0] row_mask:0xf bank_mask:0xf
    v_cvt_pk_bf16_f32 v27, v4, v5
    v_mul_f32_dpp v2, v114, v163 quad_perm:[1,0,3,2] row_mask:0xf bank_mask:0xf
    v_mul_f32_dpp v3, v118, v163 quad_perm:[1,0,3,2] row_mask:0xf bank_mask:0xf
    s_waitcnt lgkmcnt(4)
    v_mfma_f32_16x16x32_bf16 v[48:51], v[24:27], v[64:67], v[48:51]
    v_fmac_f32_dpp v2, v130, v164 quad_perm:[2,3,0,1] row_mask:0xf bank_mask:0xf
    v_fmac_f32_dpp v3, v134, v164 quad_perm:[2,3,0,1] row_mask:0xf bank_mask:0xf
    v_fmac_f32_dpp v2, v146, v165 quad_perm:[3,2,1,0] row_mask:0xf bank_mask:0xf
    v_fmac_f32_dpp v3, v150, v165 quad_perm:[3,2,1,0] row_mask:0xf bank_mask:0xf
    v_cvt_pk_bf16_f32 v28, v2, v3
    v_mul_f32_dpp v4, v122, v163 quad_perm:[1,0,3,2] row_mask:0xf bank_mask:0xf
    v_mfma_f32_16x16x32_bf16 v[52:55], v[24:27], v[68:71], v[52:55]
    v_mul_f32_dpp v5, v126, v163 quad_perm:[1,0,3,2] row_mask:0xf bank_mask:0xf
    v_fmac_f32_dpp v4, v138, v164 quad_perm:[2,3,0,1] row_mask:0xf bank_mask:0xf
    v_fmac_f32_dpp v5, v142, v164 quad_perm:[2,3,0,1] row_mask:0xf bank_mask:0xf
    v_fmac_f32_dpp v4, v154, v165 quad_perm:[3,2,1,0] row_mask:0xf bank_mask:0xf
    v_fmac_f32_dpp v5, v158, v165 quad_perm:[3,2,1,0] row_mask:0xf bank_mask:0xf
    v_cvt_pk_bf16_f32 v29, v4, v5
    v_mul_f32_dpp v2, v115, v163 quad_perm:[1,0,3,2] row_mask:0xf bank_mask:0xf
    v_mfma_f32_16x16x32_bf16 v[56:59], v[24:27], v[72:75], v[56:59]
    v_mul_f32_dpp v3, v119, v163 quad_perm:[1,0,3,2] row_mask:0xf bank_mask:0xf
    v_fmac_f32_dpp v2, v131, v164 quad_perm:[2,3,0,1] row_mask:0xf bank_mask:0xf
    v_fmac_f32_dpp v3, v135, v164 quad_perm:[2,3,0,1] row_mask:0xf bank_mask:0xf
    v_fmac_f32_dpp v2, v147, v165 quad_perm:[3,2,1,0] row_mask:0xf bank_mask:0xf
    v_fmac_f32_dpp v3, v151, v165 quad_perm:[3,2,1,0] row_mask:0xf bank_mask:0xf
    v_cvt_pk_bf16_f32 v30, v2, v3
    v_mfma_f32_16x16x32_bf16 v[60:63], v[24:27], v[76:79], v[60:63]
    v_mul_f32_dpp v4, v123, v163 quad_perm:[1,0,3,2] row_mask:0xf bank_mask:0xf
    v_mul_f32_dpp v5, v127, v163 quad_perm:[1,0,3,2] row_mask:0xf bank_mask:0xf
    v_fmac_f32_dpp v4, v139, v164 quad_perm:[2,3,0,1] row_mask:0xf bank_mask:0xf
    v_fmac_f32_dpp v5, v143, v164 quad_perm:[2,3,0,1] row_mask:0xf bank_mask:0xf
    v_fmac_f32_dpp v4, v155, v165 quad_perm:[3,2,1,0] row_mask:0xf bank_mask:0xf
    v_fmac_f32_dpp v5, v159, v165 quad_perm:[3,2,1,0] row_mask:0xf bank_mask:0xf
    v_cvt_pk_bf16_f32 v31, v4, v5
    s_lshl_b32 s28, s28, 4
    s_lshl_b32 s10, s10, 9
    s_add_u32 s8, s8, s10
    s_addc_u32 s9, s9, 0
    s_mov_b32 s10, 0xbfb8aa3b
    s_waitcnt lgkmcnt(0)
    v_mfma_f32_16x16x32_bf16 v[48:51], v[28:31], v[80:83], v[48:51]
    v_mul_f32 v8, s10, v32
    v_mul_f32 v9, s10, v36
    v_mul_f32 v10, s10, v40
    v_mul_f32 v11, s10, v44
    v_mfma_f32_16x16x32_bf16 v[52:55], v[28:31], v[84:87], v[52:55]
    v_exp_f32 v8, v8
    v_exp_f32 v9, v9
    v_exp_f32 v10, v10
    v_exp_f32 v11, v11
    v_mfma_f32_16x16x32_bf16 v[56:59], v[28:31], v[88:91], v[56:59]
    v_cmp_gt_u32 vcc, s28, v0
    v_lshrrev_b32 v6, 4, v0
    v_and_b32 v7, 15, v0
    v_add_f32 v8, 1.0, v8
    v_mfma_f32_16x16x32_bf16 v[60:63], v[28:31], v[92:95], v[60:63]
    v_add_f32 v9, 1.0, v9
    v_add_f32 v10, 1.0, v10
    v_add_f32 v11, 1.0, v11
    v_lshlrev_b32 v6, 9, v6
    v_lshl_add_u32 v6, v7, 3, v6
    s_mov_b64 exec, vcc
    v_rcp_f32 v8, v8
    v_rcp_f32 v9, v9
    v_rcp_f32 v10, v10
    v_rcp_f32 v11, v11
    v_cvt_pk_bf16_f32 v12, v32, v36
    v_cvt_pk_bf16_f32 v13, v40, v44
    global_store_dwordx2 v6, v[12:13], s[8:9] nt
    v_mul_f32 v49, v49, v8
    v_mul_f32 v53, v53, v9
    v_mul_f32 v57, v57, v10
    v_mul_f32 v61, v61, v11
    v_cvt_pk_bf16_f32 v14, v49, v53
    v_cvt_pk_bf16_f32 v15, v57, v61
    global_store_dwordx2 v6, v[14:15], s[8:9] offset:128 nt
    v_mul_f32 v50, v50, v8
    v_mul_f32 v54, v54, v9
    v_mul_f32 v58, v58, v10
    v_mul_f32 v62, v62, v11
    v_cvt_pk_bf16_f32 v16, v50, v54
    v_cvt_pk_bf16_f32 v17, v58, v62
    global_store_dwordx2 v6, v[16:17], s[8:9] offset:256 nt
    v_mul_f32 v51, v51, v8
    v_mul_f32 v55, v55, v9
    v_mul_f32 v59, v59, v10
    v_mul_f32 v63, v63, v11
    v_cvt_pk_bf16_f32 v18, v51, v55
    v_cvt_pk_bf16_f32 v19, v59, v63
    global_store_dwordx2 v6, v[18:19], s[8:9] offset:384 nt
L_fin:
L_end:
    s_endpgm
L_help:
    v_and_b32 v0, 63, v0
    s_cmp_eq_u32 s3, 11
    s_cbranch_scc1 L_h11
    v_mov_b32 v4, 0
    v_mov_b32 v5, 0
    v_mov_b32 v6, 0
    v_mov_b32 v7, 0
    v_lshlrev_b32 v47, 4, v0
    ds_write_b128 v47, v[4:7]
    ds_write_b128 v47, v[4:7] offset:2048
    s_waitcnt lgkmcnt(0)
    s_barrier
    v_mul_u32_u24 v8, 1229, v0
    v_lshrrev_b32 v8, 12, v8
    v_mul_u32_u24 v9, 10, v8
    v_add_u32 v9, 2, v9
    v_mul_u32_u24 v9, 43691, v9
    v_lshrrev_b32 v9, 17, v9
    v_sub_u32 v9, v0, v9
    v_lshlrev_b32 v8, 5, v8
    v_lshl_or_b32 v8, v9, 30, v8
    v_or_b32 v8, 0x20000000, v8
    v_lshlrev_b32 v9, 2, v0
    ds_write_b32 v9, v8 offset:1088
    s_lshl_b32 s57, s2, 11
    s_add_u32 s57, s57, 8388608
    s_add_u32 s50, s6, s57
    s_addc_u32 s51, s7, 0
    global_store_dwordx4 v47, v[4:7], s[50:51] sc1
    global_store_dwordx4 v47, v[4:7], s[50:51] offset:1024 sc1
    v_mov_b32 v96, 0
    v_mov_b32 v97, 0
    v_mov_b32 v98, 0
    v_mov_b32 v99, 0
    v_mov_b32 v100, 0
    v_mov_b32 v101, 0
    v_mov_b32 v102, 0
    v_mov_b32 v103, 0
    v_mov_b32 v104, 0
    v_mov_b32 v105, 0
    v_mov_b32 v106, 0
    v_mov_b32 v107, 0
    v_mov_b32 v108, 0
    v_mov_b32 v109, 0
    v_mov_b32 v110, 0
    v_mov_b32 v111, 0
    v_mov_b32 v112, 0
    v_mov_b32 v113, 0
    v_mov_b32 v114, 0
    v_mov_b32 v115, 0
    v_mov_b32 v116, 0
    v_mov_b32 v117, 0
    v_mov_b32 v118, 0
    v_mov_b32 v119, 0
    v_mov_b32 v120, 0
    v_mov_b32 v121, 0
    v_mov_b32 v122, 0
    v_mov_b32 v123, 0
    v_mov_b32 v124, 0
    v_mov_b32 v125, 0
    v_mov_b32 v126, 0
    v_mov_b32 v127, 0
    v_mov_b32 v128, 0
    v_mov_b32 v129, 0
    v_mov_b32 v130, 0
    v_mov_b32 v131, 0
    v_mov_b32 v132, 0
    v_mov_b32 v133, 0
    v_mov_b32 v134, 0
    v_mov_b32 v135, 0
    v_mov_b32 v136, 0
    v_mov_b32 v137, 0
    v_mov_b32 v138, 0
    v_mov_b32 v139, 0
    v_mov_b32 v140, 0
    v_mov_b32 v141, 0
    v_mov_b32 v142, 0
    v_mov_b32 v143, 0
    v_mov_b32 v144, 0
    v_mov_b32 v145, 0
    v_mov_b32 v146, 0
    v_mov_b32 v147, 0
    v_mov_b32 v148, 0
    v_mov_b32 v149, 0
    v_mov_b32 v150, 0
    v_mov_b32 v151, 0
    v_mov_b32 v152, 0
    v_mov_b32 v153, 0
    v_mov_b32 v154, 0
    v_mov_b32 v155, 0
    v_mov_b32 v156, 0
    v_mov_b32 v157, 0
    v_mov_b32 v158, 0
    v_mov_b32 v159, 0
    s_waitcnt lgkmcnt(0)
    s_barrier
    ds_read_b128 v[48:51], v47 offset:2048
    s_waitcnt lgkmcnt(0)
    v_add_u32 v52, v48, v49
    v_add_u32 v53, v52, v50
    v_add_u32 v54, v53, v51
    v_mov_b32 v55, v54
    s_nop 1
    v_add_u32_dpp v55, v55, v55 row_shr:1 row_mask:0xf bank_mask:0xf
    s_nop 1
    v_add_u32_dpp v55, v55, v55 row_shr:2 row_mask:0xf bank_mask:0xf
    s_nop 1
    v_add_u32_dpp v55, v55, v55 row_shr:4 row_mask:0xf bank_mask:0xf
    s_nop 1
    v_add_u32_dpp v55, v55, v55 row_shr:8 row_mask:0xf bank_mask:0xf
    s_nop 1
    v_add_u32_dpp v55, v55, v55 row_bcast:15 row_mask:0xa bank_mask:0xf
    s_nop 1
    v_add_u32_dpp v55, v55, v55 row_bcast:31 row_mask:0xc bank_mask:0xf
    v_sub_u32 v56, v55, v54
    v_add_u32 v57, v56, v48
    v_add_u32 v58, v56, v52
    v_add_u32 v59, v56, v53
    ds_write_b128 v47, v[56:59] offset:3072
    s_waitcnt lgkmcnt(0)
    s_barrier
    s_barrier
    s_branch L_common
L_h11:
    s_mov_b32 s73, 1
    s_load_dwordx2 s[66:67], s[0:1], 80
    v_mov_b32 v40, 0
    s_barrier
    s_waitcnt lgkmcnt(0)
    s_cmp_lg_u32 s2, 0
    s_cbranch_scc1 L_h1
    s_memrealtime s[48:49]
    s_waitcnt lgkmcnt(0)
    s_or_b32 s48, s48, 1
    v_mov_b32 v41, s48
    global_store_dword v40, v41, s[66:67] sc1
L_h1:
    v_mov_b32 v96, 0
    v_mov_b32 v97, 0
    v_mov_b32 v98, 0
    v_mov_b32 v99, 0
    v_mov_b32 v100, 0
    v_mov_b32 v101, 0
    v_mov_b32 v102, 0
    v_mov_b32 v103, 0
    v_mov_b32 v104, 0
    v_mov_b32 v105, 0
    v_mov_b32 v106, 0
    v_mov_b32 v107, 0
    v_mov_b32 v108, 0
    v_mov_b32 v109, 0
    v_mov_b32 v110, 0
    v_mov_b32 v111, 0
    v_mov_b32 v112, 0
    v_mov_b32 v113, 0
    v_mov_b32 v114, 0
    v_mov_b32 v115, 0
    v_mov_b32 v116, 0
    v_mov_b32 v117, 0
    v_mov_b32 v118, 0
    v_mov_b32 v119, 0
    v_mov_b32 v120, 0
    v_mov_b32 v121, 0
    v_mov_b32 v122, 0
    v_mov_b32 v123, 0
    v_mov_b32 v124, 0
    v_mov_b32 v125, 0
    v_mov_b32 v126, 0
    v_mov_b32 v127, 0
    v_mov_b32 v128, 0
    v_mov_b32 v129, 0
    v_mov_b32 v130, 0
    v_mov_b32 v131, 0
    v_mov_b32 v132, 0
    v_mov_b32 v133, 0
    v_mov_b32 v134, 0
    v_mov_b32 v135, 0
    v_mov_b32 v136, 0
    v_mov_b32 v137, 0
    v_mov_b32 v138, 0
    v_mov_b32 v139, 0
    v_mov_b32 v140, 0
    v_mov_b32 v141, 0
    v_mov_b32 v142, 0
    v_mov_b32 v143, 0
    v_mov_b32 v144, 0
    v_mov_b32 v145, 0
    v_mov_b32 v146, 0
    v_mov_b32 v147, 0
    v_mov_b32 v148, 0
    v_mov_b32 v149, 0
    v_mov_b32 v150, 0
    v_mov_b32 v151, 0
    v_mov_b32 v152, 0
    v_mov_b32 v153, 0
    v_mov_b32 v154, 0
    v_mov_b32 v155, 0
    v_mov_b32 v156, 0
    v_mov_b32 v157, 0
    v_mov_b32 v158, 0
    v_mov_b32 v159, 0
    s_barrier
    global_load_dword v41, v40, s[66:67] sc1
    s_barrier
    v_lshlrev_b32 v62, 3, v0
    ds_read_b64 v[48:49], v62 offset:3072
    ds_read_b64 v[50:51], v62 offset:2048
    ds_read_b64 v[52:53], v62 offset:3584
    ds_read_b64 v[54:55], v62 offset:2560
    v_lshlrev_b32 v62, 1, v62
    s_lshl_b32 s57, s2, 11
    s_add_u32 s57, s57, 8388608
    s_add_u32 s50, s6, s57
    s_addc_u32 s51, s7, 0
    s_waitcnt lgkmcnt(0)
    s_barrier
    s_branch L_common
.section .rodata,"a"
.p2align 6
.amdhsa_kernel gather_scatter__tensor_product_equiv_equiformer__graph_kernel
  .amdhsa_next_free_vgpr 168
  .amdhsa_next_free_sgpr 74
  .amdhsa_accum_offset 168
  .amdhsa_group_segment_fixed_size 0
  .amdhsa_kernarg_size 96
  .amdhsa_user_sgpr_count 2
  .amdhsa_user_sgpr_kernarg_segment_ptr 1
  .amdhsa_system_sgpr_workgroup_id_x 1
.end_amdhsa_kernel
```
